```python
import torch

def _softmax(x, axis=-1):
    return torch.softmax(x, dim=axis)
def _gelu(x):
    return torch.nn.functional.gelu(x, approximate="tanh")
def _silu(x):
    return torch.nn.functional.silu(x)
def _sigmoid(x):
    return torch.sigmoid(x)
def _layernorm(x, axis=-1, eps=1e-5):
    m = x.mean(dim=axis, keepdim=True)
    v = x.var(dim=axis, keepdim=True, unbiased=False)
    return (x - m) / torch.sqrt(v + eps)
def _scatter_add(tgt, idx, src, axis=0):
    return tgt.clone().index_add_(axis, idx, src)
def _segment_sum(src, seg, n):
    out = torch.zeros((n,) + src.shape[1:], dtype=src.dtype)
    return out.index_add_(0, seg, src)
def _pad(x, pw):
    flat = tuple(v for pair in reversed(pw) for v in pair)
    return torch.nn.functional.pad(x, flat)

kernel_name = 'parallel_sum__sliding_block_cached__mixer_channel_mlp__decode'

def setup_inputs():

    _w = (lambda a: (lambda t: t.to(torch.bfloat16) if t.is_floating_point() else t)(torch.as_tensor(a)))
    def _A_setup():
        B, Sq, D = 1, 1, 1024
        Hq, Hkv, Sk, Dh = 32, 4, 65536, 128
        assert Hq % Hkv == 0, (Hq, Hkv)
        return {
            "x": _w((lambda *s: torch.randn(*s, dtype=torch.bfloat16) * 0.05)(B, Sq, D)),
            "k_cache": _w((lambda *s: torch.randn(*s, dtype=torch.bfloat16) * 3.2)(B, Hkv, Sk, Dh)),
            "v_cache": _w((lambda *s: torch.randn(*s, dtype=torch.bfloat16) * 0.4)(B, Hkv, Sk, Dh)),
            "wq": _w((lambda *s: torch.randn(*s, dtype=torch.bfloat16) * 3.2)(D, Hq * Dh) * (D ** -0.5)),
            "wo": _w((lambda *s: torch.randn(*s, dtype=torch.bfloat16) * 0.4)(Hq * Dh, D) * ((Hq * Dh) ** -0.5)),
        }
    _A_in = _A_setup()

    def _B_setup():
        B, S, D, F = 1, 1, 1024, 3584
        return {
            "x": _w((lambda *s: torch.randn(*s, dtype=torch.bfloat16) * 0.05)(B, S, D)),
            "w1": _w((lambda *s: torch.randn(*s, dtype=torch.bfloat16) * 1.6)(D, F) * (D ** -0.5)),
            "b1": _w((lambda *s: torch.randn(*s, dtype=torch.bfloat16) * 1.6)(F)),
            "w2": _w((lambda *s: torch.randn(*s, dtype=torch.bfloat16) * 0.1)(F, D) * (F ** -0.5)),
            "b2": _w((lambda *s: torch.randn(*s, dtype=torch.bfloat16) * 0.1)(D)),
        }
    _B_in = _B_setup()

    return {
        "A_x": _A_in["x"],
        "A_k_cache": _A_in["k_cache"],
        "A_v_cache": _A_in["v_cache"],
        "A_wq": _A_in["wq"],
        "A_wo": _A_in["wo"],
        "B_x": _B_in["x"],
        "B_w1": _B_in["w1"],
        "B_b1": _B_in["b1"],
        "B_w2": _B_in["w2"],
        "B_b2": _B_in["b2"],
    }

def reference(A_x, A_k_cache, A_v_cache, A_wq, A_wo, B_x, B_w1, B_b1, B_w2, B_b2):
    def _A_ref(x, k_cache, v_cache, wq, wo):
        B, Sq, D = x.shape
        Hq, Dh = 32, 128
        Hkv, Sk = k_cache.shape[1], k_cache.shape[2]
        W = min(4096, max(256, Sk // 4))
        rep = Hq // Hkv
        q = (lambda x, *d: x.permute(*d))((x @ wq).reshape(B, Sq, Hq, Dh), 0, 2, 1, 3)
        k = (lambda x, n, axis: torch.repeat_interleave(x, n, dim=axis))(k_cache[:, :, Sk - W:, :], rep, axis=1)
        v = (lambda x, n, axis: torch.repeat_interleave(x, n, dim=axis))(v_cache[:, :, Sk - W:, :], rep, axis=1)
        scores = torch.einsum("bhqd,bhkd->bhqk", q, k) * (Dh ** -0.5)
        p = _softmax(scores, axis=-1)
        o = torch.einsum("bhqk,bhkd->bhqd", p, v)
        return (lambda x, *d: x.permute(*d))(o, 0, 2, 1, 3).reshape(B, Sq, Hq * Dh) @ wo

    def _B_ref(x, w1, b1, w2, b2):
        y = _layernorm(x, axis=-1)
        h = _gelu(torch.einsum("bsd,df->bsf", y, w1) + b1)
        return torch.einsum("bsf,fd->bsd", h, w2) + b2

    x = A_x
    xn = _layernorm(x, axis=-1)
    return x + _A_ref(xn, A_k_cache, A_v_cache, A_wq, A_wo) + _B_ref(xn, B_w1, B_b1, B_w2, B_b2)
```

```asm
; @launch grid=(256,1,1) block=(320,1,1) lds=74304
.amdgcn_target "amdgcn-amd-amdhsa--gfx950"
.text
.globl parallel_sum__sliding_block_cached__mixer_channel_mlp__decode_kernel
.p2align 8
.type parallel_sum__sliding_block_cached__mixer_channel_mlp__decode_kernel,@function
parallel_sum__sliding_block_cached__mixer_channel_mlp__decode_kernel:
    s_cmp_ge_u32 s2, 256
    s_cbranch_scc1 L_end
    s_load_dwordx16 s[16:31], s[0:1], 0
    s_load_dwordx8 s[32:39], s[0:1], 64
    s_load_dwordx2 s[40:41], s[0:1], 96
    v_lshrrev_b32 v1, 6, v0
    v_and_b32 v0, 63, v0
    v_lshlrev_b32 v2, 5, v0
    v_readfirstlane_b32 s3, v1
    s_and_b32 s4, s2, 7
    s_lshr_b32 s5, s2, 3
    s_and_b32 s6, s5, 1
    s_lshr_b32 s10, s4, 2
    s_mul_i32 s10, s10, 3
    s_xor_b32 s10, s4, s10
    s_lshl_b32 s7, s10, 4
    s_lshr_b32 s10, s5, 1
    s_add_u32 s7, s7, s10
    s_sub_u32 s11, s3, 1
    s_cmp_eq_u32 s3, 0
    s_cbranch_scc1 L_nopf
    s_and_b32 s10, s5, 0
    s_cbranch_scc1 L_nopf
    s_getpc_b64 s[44:45]
L_pc0:
    s_sub_u32 s44, s44, L_pc0-parallel_sum__sliding_block_cached__mixer_channel_mlp__decode_kernel
    s_subb_u32 s45, s45, 0
    s_lshl_b32 s10, s11, 12
    v_lshlrev_b32 v1, 4, v0
    v_add_u32 v1, s10, v1
    global_load_dwordx4 v[100:103], v1, s[44:45] offset:0
    global_load_dwordx4 v[100:103], v1, s[44:45] offset:1024
    global_load_dwordx4 v[100:103], v1, s[44:45] offset:2048
    global_load_dwordx4 v[100:103], v1, s[44:45] offset:3072
L_nopf:
    s_and_b32 s9, s7, 1
    s_lshr_b32 s8, s7, 1
    v_lshrrev_b32 v3, 3, v0
    s_lshl_b32 s10, s11, 3
    v_add_u32 v3, s10, v3
    v_and_b32 v5, 7, v0
    v_lshlrev_b32 v5, 4, v5
    v_lshl_add_u32 v4, v3, 13, v5
    s_lshr_b32 s90, s5, 2
    s_lshl_b32 s90, s90, 3
    s_and_b32 s10, s4, 1
    s_lshl_b32 s10, s10, 2
    s_or_b32 s90, s90, s10
    s_lshr_b32 s10, s4, 1
    s_or_b32 s90, s90, s10
    s_xor_b32 s90, s90, 3
    s_bfe_u32 s91, s5, 0x10001
    s_and_b32 s42, s5, 3
    s_mul_i32 s96, s6, 0
    s_add_u32 s96, s96, 8
    s_mul_i32 s96, s96, s91
    s_mul_i32 s10, s6, 16
    s_add_u32 s96, s96, s10
    s_lshl_b32 s12, s96, 18
    s_lshl_b32 s10, s90, 7
    s_add_u32 s12, s12, s10
    s_cmp_eq_u32 s3, 0
    s_waitcnt lgkmcnt(0)
    s_cbranch_scc0 L_nox
    global_load_dwordx4 v[8:11], v2, s[16:17]
    global_load_dwordx4 v[12:15], v2, s[16:17] offset:16
    v_mov_b32 v1, 0
    global_load_dword v7, v1, s[40:41] sc1
    s_branch L_H
L_nox:
    s_mov_b32 s44, s22
    s_mov_b32 s45, s23
    s_mov_b32 s46, 8388608
    s_mov_b32 s47, 0x00020000
    buffer_load_dwordx4 v[192:195], v4, s[44:47], s12 offen nt
    s_add_u32 s12, s12, 262144
    buffer_load_dwordx4 v[196:199], v4, s[44:47], s12 offen nt
    s_add_u32 s12, s12, 262144
    buffer_load_dwordx4 v[200:203], v4, s[44:47], s12 offen nt
    s_add_u32 s12, s12, 262144
    buffer_load_dwordx4 v[204:207], v4, s[44:47], s12 offen nt
    s_add_u32 s12, s12, 262144
    buffer_load_dwordx4 v[208:211], v4, s[44:47], s12 offen nt
    s_add_u32 s12, s12, 262144
    buffer_load_dwordx4 v[212:215], v4, s[44:47], s12 offen nt
    s_add_u32 s12, s12, 262144
    buffer_load_dwordx4 v[216:219], v4, s[44:47], s12 offen nt
    s_add_u32 s12, s12, 262144
    buffer_load_dwordx4 v[220:223], v4, s[44:47], s12 offen nt
    s_add_u32 s12, s12, 262144
    s_barrier
    s_mov_b32 s48, s40
    s_mov_b32 s49, s41
    s_mov_b32 s50, 268435456
    s_mov_b32 s51, 0x00020000
    s_cmp_eq_u32 s6, 1
    s_cbranch_scc1 L_YG
    s_mov_b32 s52, s18
    s_mov_b32 s53, s19
    s_mov_b32 s54, 67108864
    s_mov_b32 s55, 0x00020000
    s_mov_b32 s56, s20
    s_mov_b32 s57, s21
    s_mov_b32 s58, 67108864
    s_mov_b32 s59, 0x00020000
    s_lshr_b32 s62, s7, 5
    s_and_b32 s63, s7, 31
    s_lshl_b32 s14, s62, 24
    s_lshl_b32 s10, s63, 15
    s_add_u32 s14, s14, s10
    s_add_u32 s14, s14, 15728640
    s_lshl_b32 s13, s11, 13
    v_lshrrev_b32 v1, 4, v0
    v_and_b32 v2, 15, v0
    v_xor_b32 v5, v2, v1
    v_lshlrev_b32 v5, 4, v5
    v_lshl_add_u32 v5, v1, 8, v5
    v_add_u32 v5, s13, v5
    v_lshlrev_b32 v6, 1, v1
    v_xor_b32 v6, v2, v6
    v_lshlrev_b32 v6, 4, v6
    v_lshl_add_u32 v6, v1, 8, v6
    v_add_u32 v6, s13, v6
    s_lshl_b32 s10, s96, 6
    v_lshlrev_b32 v9, 1, v3
    v_add_u32 v30, 65536, v9
    v_add_u32 v30, s10, v30
    v_and_b32 v1, 1, v0
    v_cmp_eq_u32 vcc, 1, v1
    v_mov_b32 v1, 0x0c0c0100
    v_mov_b32 v2, 0x01000c0c
    v_cndmask_b32 v18, v1, v2, vcc
    v_mov_b32 v1, 0x0c0c0302
    v_mov_b32 v2, 0x03020c0c
    v_cndmask_b32 v19, v1, v2, vcc
    v_bfe_u32 v1, v0, 1, 2
    v_mov_b32 v2, 0x0c0c0c0c
    v_cmp_eq_u32 vcc, 0, v1
    s_nop 1
    v_cndmask_b32 v10, v2, v18, vcc
    v_cndmask_b32 v11, v2, v19, vcc
    v_cmp_eq_u32 vcc, 1, v1
    s_nop 1
    v_cndmask_b32 v12, v2, v18, vcc
    v_cndmask_b32 v13, v2, v19, vcc
    v_cmp_eq_u32 vcc, 2, v1
    s_nop 1
    v_cndmask_b32 v14, v2, v18, vcc
    v_cndmask_b32 v15, v2, v19, vcc
    v_cmp_eq_u32 vcc, 3, v1
    s_nop 1
    v_cndmask_b32 v16, v2, v18, vcc
    v_cndmask_b32 v17, v2, v19, vcc
    v_mov_b32 v26, 74240
    v_mov_b32 v27, 1
    v_lshlrev_b32 v28, 4, v0
    s_lshl_b32 s10, s11, 10
    v_add_u32 v28, s10, v28
    v_add_u32 v28, 67584, v28
    s_mov_b32 s60, 1048576
L_gx_1:
    ds_read_b32 v1, v26 offset:16
    s_sub_u32 s60, s60, 1
    s_cbranch_scc1 L_end
    s_waitcnt lgkmcnt(0)
    v_cmp_gt_u32 vcc, 1, v1
    s_cbranch_vccnz L_gx_1
    ds_read_u16 v40, v30 offset:0
    ds_read_u16 v41, v30 offset:64
    ds_read_u16 v42, v30 offset:128
    ds_read_u16 v43, v30 offset:192
    ds_read_u16 v44, v30 offset:256
    ds_read_u16 v45, v30 offset:320
    ds_read_u16 v46, v30 offset:384
    ds_read_u16 v47, v30 offset:448
    ds_read_b32 v29, v26 offset:24
    s_waitcnt lgkmcnt(0)
    v_readfirstlane_b32 s64, v29
    v_perm_b32 v32, v40, v40, v10
    v_perm_b32 v33, v40, v40, v12
    v_perm_b32 v34, v40, v40, v14
    v_perm_b32 v35, v40, v40, v16
    v_perm_b32 v36, v41, v41, v10
    v_perm_b32 v37, v41, v41, v12
    v_perm_b32 v38, v41, v41, v14
    v_perm_b32 v39, v41, v41, v16
    s_waitcnt vmcnt(7)
    v_mfma_f32_16x16x32_bf16 v[18:21], v[32:35], v[192:195], 0
    s_add_u32 s10, s13, 0
    s_mov_b32 m0, s10
    v_xor_b32 v1, 0, v5
    buffer_load_dwordx4 v1, s[52:55], s14 offen offset:0 nt lds
    v_perm_b32 v32, v42, v42, v10
    v_perm_b32 v33, v42, v42, v12
    v_perm_b32 v34, v42, v42, v14
    v_perm_b32 v35, v42, v42, v16
    s_waitcnt vmcnt(7)
    v_mfma_f32_16x16x32_bf16 v[18:21], v[36:39], v[196:199], v[18:21]
    v_xor_b32 v1, 64, v5
    buffer_load_dwordx4 v1, s[52:55], s14 offen offset:1024 nt lds
    v_perm_b32 v36, v43, v43, v10
    v_perm_b32 v37, v43, v43, v12
    v_perm_b32 v38, v43, v43, v14
    v_perm_b32 v39, v43, v43, v16
    s_waitcnt vmcnt(7)
    v_mfma_f32_16x16x32_bf16 v[18:21], v[32:35], v[200:203], v[18:21]
    v_xor_b32 v1, 128, v5
    buffer_load_dwordx4 v1, s[52:55], s14 offen offset:2048 nt lds
    v_perm_b32 v32, v44, v44, v10
    v_perm_b32 v33, v44, v44, v12
    v_perm_b32 v34, v44, v44, v14
    v_perm_b32 v35, v44, v44, v16
    s_waitcnt vmcnt(7)
    v_mfma_f32_16x16x32_bf16 v[18:21], v[36:39], v[204:207], v[18:21]
    v_xor_b32 v1, 192, v5
    buffer_load_dwordx4 v1, s[52:55], s14 offen offset:3072 nt lds
    v_perm_b32 v36, v45, v45, v10
    v_perm_b32 v37, v45, v45, v12
    v_perm_b32 v38, v45, v45, v14
    v_perm_b32 v39, v45, v45, v16
    s_waitcnt vmcnt(7)
    v_mfma_f32_16x16x32_bf16 v[18:21], v[32:35], v[208:211], v[18:21]
    s_add_u32 s10, s13, 4096
    s_mov_b32 m0, s10
    s_add_u32 s14, s14, 4096
    v_xor_b32 v1, 0, v5
    buffer_load_dwordx4 v1, s[52:55], s14 offen offset:0 nt lds
    v_perm_b32 v32, v46, v46, v10
    v_perm_b32 v33, v46, v46, v12
    v_perm_b32 v34, v46, v46, v14
    v_perm_b32 v35, v46, v46, v16
    s_waitcnt vmcnt(7)
    v_mfma_f32_16x16x32_bf16 v[18:21], v[36:39], v[212:215], v[18:21]
    v_xor_b32 v1, 64, v5
    buffer_load_dwordx4 v1, s[52:55], s14 offen offset:1024 nt lds
    v_perm_b32 v36, v47, v47, v10
    v_perm_b32 v37, v47, v47, v12
    v_perm_b32 v38, v47, v47, v14
    v_perm_b32 v39, v47, v47, v16
    s_waitcnt vmcnt(7)
    v_mfma_f32_16x16x32_bf16 v[18:21], v[32:35], v[216:219], v[18:21]
    v_xor_b32 v1, 128, v5
    buffer_load_dwordx4 v1, s[52:55], s14 offen offset:2048 nt lds
    s_waitcnt vmcnt(7)
    v_mfma_f32_16x16x32_bf16 v[18:21], v[36:39], v[220:223], v[18:21]
    v_xor_b32 v1, 192, v5
    buffer_load_dwordx4 v1, s[52:55], s14 offen offset:3072 nt lds
    s_nop 7
    ds_write_b128 v28, v[18:21]
    s_mov_b64 exec, 1
    ds_add_u32 v26, v27 offset:0
    s_mov_b64 exec, -1
    v_and_b32 v22, 15, v0
    v_lshrrev_b32 v23, 4, v0
    v_or_b32 v1, 0, v23
    v_xor_b32 v1, v1, v22
    v_lshlrev_b32 v1, 4, v1
    v_lshl_add_u32 v32, v22, 8, v1
    v_add_u32 v32, s13, v32
    v_or_b32 v1, 4, v23
    v_xor_b32 v1, v1, v22
    v_lshlrev_b32 v1, 4, v1
    v_lshl_add_u32 v33, v22, 8, v1
    v_add_u32 v33, s13, v33
    v_or_b32 v1, 8, v23
    v_xor_b32 v1, v1, v22
    v_lshlrev_b32 v1, 4, v1
    v_lshl_add_u32 v34, v22, 8, v1
    v_add_u32 v34, s13, v34
    v_or_b32 v1, 12, v23
    v_xor_b32 v1, v1, v22
    v_lshlrev_b32 v1, 4, v1
    v_lshl_add_u32 v35, v22, 8, v1
    v_add_u32 v35, s13, v35
    v_bfe_u32 v1, v0, 2, 2
    v_lshl_add_u32 v1, v23, 2, v1
    v_and_b32 v2, 7, v1
    v_lshlrev_b32 v1, 8, v1
    v_and_b32 v24, 3, v0
    v_lshl_add_u32 v1, v24, 3, v1
    v_add_u32 v1, 32768, v1
    v_add_u32 v1, s13, v1
    v_xor_b32 v24, 0, v2
    v_lshl_add_u32 v40, v24, 5, v1
    v_xor_b32 v24, 1, v2
    v_lshl_add_u32 v41, v24, 5, v1
    v_xor_b32 v24, 2, v2
    v_lshl_add_u32 v42, v24, 5, v1
    v_xor_b32 v24, 3, v2
    v_lshl_add_u32 v43, v24, 5, v1
    v_xor_b32 v24, 4, v2
    v_lshl_add_u32 v44, v24, 5, v1
    v_xor_b32 v24, 5, v2
    v_lshl_add_u32 v45, v24, 5, v1
    v_xor_b32 v24, 6, v2
    v_lshl_add_u32 v46, v24, 5, v1
    v_xor_b32 v24, 7, v2
    v_lshl_add_u32 v47, v24, 5, v1
    s_lshl_b32 s65, s62, 15
    s_lshl_b32 s10, s11, 11
    s_add_u32 s65, s65, s10
    s_add_u32 s65, s65, 65536
    s_add_u32 s66, s65, 8192
    s_add_u32 s88, s65, 16384
    s_add_u32 s89, s65, 24576
    v_lshlrev_b32 v55, 4, v0
    v_lshlrev_b32 v56, 2, v0
    s_lshl_b32 s10, s11, 9
    v_add_u32 v56, s10, v56
    v_add_u32 v56, 71680, v56
    v_and_b32 v1, 7, v0
    v_lshlrev_b32 v57, 8, v1
    v_lshl_add_u32 v57, v23, 4, v57
    v_add_u32 v57, 71680, v57
    v_add_u32 v58, s13, v55
    v_lshl_add_u32 v24, v23, 4, v1
    v_lshlrev_b32 v24, 4, v24
    v_bfe_u32 v2, v0, 3, 1
    v_lshl_add_u32 v24, v2, 10, v24
    s_lshl_b32 s10, s11, 11
    v_add_u32 v24, s10, v24
    v_lshlrev_b32 v25, 3, v1
    v_add_u32 v25, 73984, v25
    s_lshl_b32 s10, s11, 6
    v_add_u32 v52, s10, v25
    s_lshl_b32 s10, s62, 3
    v_add_u32 v1, s10, v1
    v_lshlrev_b32 v53, 14, v1
    v_lshl_add_u32 v53, v2, 6, v53
    v_lshl_add_u32 v53, v23, 4, v53
    s_lshr_b32 s10, s11, 1
    s_lshl_b32 s67, s10, 13
    s_lshl_b32 s10, s63, 8
    s_add_u32 s67, s67, s10
    s_and_b32 s10, s11, 1
    s_lshl_b32 s10, s10, 7
    s_add_u32 s67, s67, s10
    s_add_u32 s67, s67, 1048576
    v_lshl_add_u32 v54, v1, 1, v2
    v_lshlrev_b32 v54, 11, v54
    v_lshl_add_u32 v54, v23, 4, v54
    s_lshl_b32 s43, s63, 6
    s_add_u32 s43, s43, 393216
    s_lshl_b32 s10, s11, 1
    s_lshl_b32 s92, 0x03030303, s10
    v_and_b32 v1, 8, v0
    v_cmp_eq_u32 vcc, 0, v1
    v_mov_b32 v2, 0x0c0c0c0c
    s_nop 0
    v_cndmask_b32 v10, v2, v10, vcc
    v_cndmask_b32 v11, v2, v11, vcc
    v_cndmask_b32 v12, v2, v12, vcc
    v_cndmask_b32 v13, v2, v13, vcc
    v_cndmask_b32 v14, v2, v14, vcc
    v_cndmask_b32 v15, v2, v15, vcc
    v_cndmask_b32 v16, v2, v16, vcc
    v_cndmask_b32 v17, v2, v17, vcc
    s_mul_i32 s15, s8, 131072
    s_lshl_b32 s10, s9, 10
    s_add_u32 s15, s15, s10
    v_lshrrev_b32 v1, 4, v0
    v_lshlrev_b32 v8, 11, v1
    v_and_b32 v2, 15, v0
    v_lshl_add_u32 v8, v2, 4, v8
    s_lshl_b32 s10, s11, 8
    v_add_u32 v8, s10, v8
    s_lshl_b32 s10, s9, 6
    s_lshl_b32 s61, s11, 4
    s_add_u32 s10, s10, s61
    v_add_u32 v2, s10, v2
    v_lshlrev_b32 v9, 13, v2
    v_and_b32 v2, 1, v1
    v_lshl_add_u32 v9, v2, 5, v9
    v_lshrrev_b32 v2, 1, v1
    v_lshl_add_u32 v9, v2, 4, v9
    s_lshl_b32 s61, s8, 6
    s_add_u32 s61, s61, 2097152
    v_lshlrev_b32 v1, 5, v1
    v_add_u32 v31, 73728, v1
    s_mov_b32 s44, s24
    s_mov_b32 s45, s25
    s_mov_b32 s46, 8388608
    s_mov_b32 s47, 0x00020000
    s_mov_b32 s94, 0x3db504f3
    s_mov_b32 s95, 0x3db504f3
    s_mov_b32 s93, 0x3fb8aa3b
    s_waitcnt vmcnt(7)
    s_add_u32 s10, s13, 32768
    s_mov_b32 m0, s10
    s_sub_u32 s14, s14, 4096
    v_xor_b32 v1, 0, v6
    buffer_load_dwordx4 v1, s[56:59], s14 offen offset:0 nt lds
    s_waitcnt vmcnt(7)
    v_xor_b32 v1, 128, v6
    buffer_load_dwordx4 v1, s[56:59], s14 offen offset:1024 nt lds
    s_waitcnt vmcnt(7)
    v_xor_b32 v1, 0, v6
    buffer_load_dwordx4 v1, s[56:59], s14 offen offset:2048 nt lds
    s_waitcnt vmcnt(7)
    v_xor_b32 v1, 128, v6
    buffer_load_dwordx4 v1, s[56:59], s14 offen offset:3072 nt lds
    s_waitcnt vmcnt(7)
    s_add_u32 s10, s13, 36864
    s_mov_b32 m0, s10
    s_add_u32 s14, s14, 4096
    v_xor_b32 v1, 0, v6
    buffer_load_dwordx4 v1, s[56:59], s14 offen offset:0 nt lds
    s_waitcnt vmcnt(7)
    v_xor_b32 v1, 128, v6
    buffer_load_dwordx4 v1, s[56:59], s14 offen offset:1024 nt lds
    s_waitcnt vmcnt(7)
    v_xor_b32 v1, 0, v6
    buffer_load_dwordx4 v1, s[56:59], s14 offen offset:2048 nt lds
    s_waitcnt vmcnt(7)
    v_xor_b32 v1, 128, v6
    buffer_load_dwordx4 v1, s[56:59], s14 offen offset:3072 nt lds
    s_waitcnt vmcnt(8)
    ds_read_b128 v[64:67], v32 offset:0
    ds_read_b128 v[68:71], v33 offset:0
    ds_read_b128 v[72:75], v34 offset:0
    ds_read_b128 v[76:79], v35 offset:0
    ds_read_b128 v[80:83], v32 offset:4096
    ds_read_b128 v[84:87], v33 offset:4096
    ds_read_b128 v[88:91], v34 offset:4096
    ds_read_b128 v[92:95], v35 offset:4096
    s_waitcnt vmcnt(7)
    buffer_load_dwordx4 v[192:195], v55, s[48:51], s65 offen offset:0 sc1
    s_waitcnt vmcnt(7)
    buffer_load_dwordx4 v[196:199], v55, s[48:51], s65 offen offset:1024 sc1
    s_waitcnt vmcnt(7)
    buffer_load_dwordx4 v[200:203], v55, s[48:51], s66 offen offset:0 sc1
    s_waitcnt vmcnt(7)
    buffer_load_dwordx4 v[204:207], v55, s[48:51], s66 offen offset:1024 sc1
    s_waitcnt vmcnt(7)
    buffer_load_dwordx4 v[208:211], v55, s[48:51], s88 offen offset:0 sc1
    s_waitcnt vmcnt(7)
    buffer_load_dwordx4 v[212:215], v55, s[48:51], s88 offen offset:1024 sc1
    s_waitcnt vmcnt(7)
    buffer_load_dwordx4 v[216:219], v55, s[48:51], s89 offen offset:0 sc1
    s_waitcnt vmcnt(7)
    buffer_load_dwordx4 v[220:223], v55, s[48:51], s89 offen offset:1024 sc1
    s_waitcnt vmcnt(0)
    s_mov_b32 s60, 1048576
L_qchk:
    v_min3_u32 v1, v193, v195, s64
    v_max3_u32 v2, v193, v195, s64
    v_min3_u32 v1, v1, v197, v199
    v_max3_u32 v2, v2, v197, v199
    v_min3_u32 v1, v1, v201, v203
    v_max3_u32 v2, v2, v201, v203
    v_min3_u32 v1, v1, v205, v207
    v_max3_u32 v2, v2, v205, v207
    v_min3_u32 v1, v1, v209, v211
    v_max3_u32 v2, v2, v209, v211
    v_min3_u32 v1, v1, v213, v215
    v_max3_u32 v2, v2, v213, v215
    v_min3_u32 v1, v1, v217, v219
    v_max3_u32 v2, v2, v217, v219
    v_min3_u32 v1, v1, v221, v223
    v_max3_u32 v2, v2, v221, v223
    v_cmp_ne_u32 vcc, v1, v2
    s_cbranch_vccz L_qok
    s_sleep 2
    buffer_load_dwordx4 v[192:195], v55, s[48:51], s65 offen offset:0 sc1
    buffer_load_dwordx4 v[196:199], v55, s[48:51], s65 offen offset:1024 sc1
    buffer_load_dwordx4 v[200:203], v55, s[48:51], s66 offen offset:0 sc1
    buffer_load_dwordx4 v[204:207], v55, s[48:51], s66 offen offset:1024 sc1
    buffer_load_dwordx4 v[208:211], v55, s[48:51], s88 offen offset:0 sc1
    buffer_load_dwordx4 v[212:215], v55, s[48:51], s88 offen offset:1024 sc1
    buffer_load_dwordx4 v[216:219], v55, s[48:51], s89 offen offset:0 sc1
    buffer_load_dwordx4 v[220:223], v55, s[48:51], s89 offen offset:1024 sc1
    s_sub_u32 s60, s60, 1
    s_cbranch_scc1 L_end
    s_waitcnt vmcnt(0)
    s_branch L_qchk
L_qok:
    v_add_f32 v192, v192, v200
    v_add_f32 v194, v194, v202
    v_add_f32 v196, v196, v204
    v_add_f32 v198, v198, v206
    v_add_f32 v192, v192, v208
    v_add_f32 v194, v194, v210
    v_add_f32 v196, v196, v212
    v_add_f32 v198, v198, v214
    v_add_f32 v192, v192, v216
    v_add_f32 v194, v194, v218
    v_add_f32 v196, v196, v220
    v_add_f32 v198, v198, v222
    v_cvt_pk_bf16_f32 v192, v192, v194
    v_cvt_pk_bf16_f32 v196, v196, v198
    ds_write_b32 v56, v192
    ds_write_b32 v56, v196 offset:256
    s_mov_b64 exec, 1
    ds_add_u32 v26, v27 offset:4
    s_mov_b64 exec, -1
    s_mov_b32 s60, 1048576
L_xq_2:
    ds_read_b32 v1, v26 offset:4
    s_sub_u32 s60, s60, 1
    s_cbranch_scc1 L_end
    s_waitcnt lgkmcnt(0)
    v_cmp_gt_u32 vcc, 4, v1
    s_cbranch_vccnz L_xq_2
    ds_read_b128 v[208:211], v57 offset:0
    ds_read_b128 v[212:215], v57 offset:64
    ds_read_b128 v[216:219], v57 offset:128
    ds_read_b128 v[220:223], v57 offset:192
    s_waitcnt lgkmcnt(0)
    v_mfma_f32_16x16x32_bf16 v[32:35], v[64:67], v[208:211], 0
    v_mfma_f32_16x16x32_bf16 v[36:39], v[80:83], v[208:211], 0
    v_mfma_f32_16x16x32_bf16 v[32:35], v[68:71], v[212:215], v[32:35]
    v_mfma_f32_16x16x32_bf16 v[36:39], v[84:87], v[212:215], v[36:39]
    v_mfma_f32_16x16x32_bf16 v[32:35], v[72:75], v[216:219], v[32:35]
    v_mfma_f32_16x16x32_bf16 v[36:39], v[88:91], v[216:219], v[36:39]
    v_mfma_f32_16x16x32_bf16 v[32:35], v[76:79], v[220:223], v[32:35]
    v_mfma_f32_16x16x32_bf16 v[36:39], v[92:95], v[220:223], v[36:39]
    s_waitcnt vmcnt(0)
    ds_read_b64_tr_b16 v[96:97], v40
    ds_read_b64_tr_b16 v[98:99], v40 offset:4096
    ds_read_b64_tr_b16 v[100:101], v41
    ds_read_b64_tr_b16 v[102:103], v41 offset:4096
    ds_read_b64_tr_b16 v[104:105], v42
    ds_read_b64_tr_b16 v[106:107], v42 offset:4096
    ds_read_b64_tr_b16 v[108:109], v43
    ds_read_b64_tr_b16 v[110:111], v43 offset:4096
    ds_read_b64_tr_b16 v[112:113], v44
    ds_read_b64_tr_b16 v[114:115], v44 offset:4096
    ds_read_b64_tr_b16 v[116:117], v45
    ds_read_b64_tr_b16 v[118:119], v45 offset:4096
    ds_read_b64_tr_b16 v[120:121], v46
    ds_read_b64_tr_b16 v[122:123], v46 offset:4096
    ds_read_b64_tr_b16 v[124:125], v47
    ds_read_b64_tr_b16 v[126:127], v47 offset:4096
    buffer_load_dwordx4 v[128:131], v8, s[44:47], s15 offen nt
    s_add_u32 s15, s15, 8192
    buffer_load_dwordx4 v[132:135], v8, s[44:47], s15 offen nt
    s_add_u32 s15, s15, 8192
    buffer_load_dwordx4 v[136:139], v8, s[44:47], s15 offen nt
    s_add_u32 s15, s15, 8192
    buffer_load_dwordx4 v[140:143], v8, s[44:47], s15 offen nt
    s_add_u32 s15, s15, 8192
    v_cvt_pk_bf16_f32 v224, v32, v33
    v_cvt_pk_bf16_f32 v225, v34, v35
    v_cvt_pk_bf16_f32 v226, v36, v37
    v_cvt_pk_bf16_f32 v227, v38, v39
    v_lshlrev_b32 v32, 16, v224
    v_and_b32 v33, 0xffff0000, v224
    v_lshlrev_b32 v34, 16, v225
    v_and_b32 v35, 0xffff0000, v225
    v_lshlrev_b32 v36, 16, v226
    v_and_b32 v37, 0xffff0000, v226
    v_lshlrev_b32 v38, 16, v227
    v_and_b32 v39, 0xffff0000, v227
    v_pk_mul_f32 v[32:33], v[32:33], s[94:95]
    v_pk_mul_f32 v[34:35], v[34:35], s[94:95]
    v_pk_mul_f32 v[36:37], v[36:37], s[94:95]
    v_pk_mul_f32 v[38:39], v[38:39], s[94:95]
    v_cvt_pk_bf16_f32 v224, v32, v33
    v_cvt_pk_bf16_f32 v225, v34, v35
    v_cvt_pk_bf16_f32 v226, v36, v37
    v_cvt_pk_bf16_f32 v227, v38, v39
    v_lshlrev_b32 v32, 16, v224
    v_and_b32 v33, 0xffff0000, v224
    v_lshlrev_b32 v34, 16, v225
    v_and_b32 v35, 0xffff0000, v225
    v_lshlrev_b32 v36, 16, v226
    v_and_b32 v37, 0xffff0000, v226
    v_lshlrev_b32 v38, 16, v227
    v_and_b32 v39, 0xffff0000, v227
    v_max3_f32 v60, v32, v33, v34
    v_max3_f32 v61, v35, v36, v37
    v_max3_f32 v60, v60, v38, v39
    v_max_f32 v60, v60, v61
    v_mov_b32 v61, v60
    s_nop 1
    v_permlane16_swap_b32 v60, v61
    s_nop 0
    v_max_f32 v60, v60, v61
    v_mov_b32 v61, v60
    s_nop 1
    v_permlane32_swap_b32 v60, v61
    s_nop 0
    v_max_f32 v60, v60, v61
    v_mul_f32 v60, s93, v60
    v_fma_f32 v32, v32, s93, -v60
    v_fma_f32 v33, v33, s93, -v60
    v_fma_f32 v34, v34, s93, -v60
    v_fma_f32 v35, v35, s93, -v60
    v_fma_f32 v36, v36, s93, -v60
    v_fma_f32 v37, v37, s93, -v60
    v_fma_f32 v38, v38, s93, -v60
    v_fma_f32 v39, v39, s93, -v60
    v_exp_f32 v32, v32
    v_exp_f32 v33, v33
    v_exp_f32 v34, v34
    v_exp_f32 v35, v35
    v_exp_f32 v36, v36
    v_exp_f32 v37, v37
    v_exp_f32 v38, v38
    v_exp_f32 v39, v39
    s_nop 0
    v_cvt_pk_bf16_f32 v224, v32, v33
    v_cvt_pk_bf16_f32 v225, v34, v35
    v_cvt_pk_bf16_f32 v226, v36, v37
    v_cvt_pk_bf16_f32 v227, v38, v39
    s_waitcnt lgkmcnt(0)
    s_nop 0
    v_mfma_f32_16x16x32_bf16 v[192:195], v[96:99], v[224:227], 0
    v_mfma_f32_16x16x32_bf16 v[196:199], v[100:103], v[224:227], 0
    v_mfma_f32_16x16x32_bf16 v[200:203], v[104:107], v[224:227], 0
    v_mfma_f32_16x16x32_bf16 v[204:207], v[108:111], v[224:227], 0
    v_mfma_f32_16x16x32_bf16 v[208:211], v[112:115], v[224:227], 0
    v_mfma_f32_16x16x32_bf16 v[212:215], v[116:119], v[224:227], 0
    v_mfma_f32_16x16x32_bf16 v[216:219], v[120:123], v[224:227], 0
    v_mfma_f32_16x16x32_bf16 v[220:223], v[124:127], v[224:227], 0
    v_pk_add_f32 v[32:33], v[32:33], v[34:35]
    v_pk_add_f32 v[36:37], v[36:37], v[38:39]
    v_pk_add_f32 v[32:33], v[32:33], v[36:37]
    v_add_f32 v61, v32, v33
    v_mov_b32 v62, v61
    s_nop 1
    v_permlane16_swap_b32 v61, v62
    s_nop 0
    v_add_f32 v61, v61, v62
    v_mov_b32 v62, v61
    s_nop 1
    v_permlane32_swap_b32 v61, v62
    s_nop 0
    v_add_f32 v61, v61, v62
    ds_write_b64 v52, v[60:61]
    s_mov_b32 exec_lo, 0xff00ff
    s_mov_b32 exec_hi, 0xff00ff
    ds_write_b128 v58, v[192:195] offset:0
    ds_write_b128 v58, v[196:199] offset:1024
    ds_write_b128 v58, v[200:203] offset:2048
    ds_write_b128 v58, v[204:207] offset:3072
    ds_write_b128 v58, v[208:211] offset:4096
    ds_write_b128 v58, v[212:215] offset:5120
    ds_write_b128 v58, v[216:219] offset:6144
    ds_write_b128 v58, v[220:223] offset:7168
    s_mov_b64 exec, 1
    ds_add_u32 v26, v27 offset:8
    s_mov_b64 exec, -1
    buffer_load_dwordx4 v[144:147], v8, s[44:47], s15 offen nt
    s_add_u32 s15, s15, 8192
    buffer_load_dwordx4 v[148:151], v8, s[44:47], s15 offen nt
    s_add_u32 s15, s15, 8192
    s_mov_b32 s60, 1048576
L_xc_3:
    ds_read_b32 v1, v26 offset:8
    s_sub_u32 s60, s60, 1
    s_cbranch_scc1 L_end
    s_waitcnt lgkmcnt(0)
    v_cmp_gt_u32 vcc, 4, v1
    s_cbranch_vccnz L_xc_3
    ds_read_b64 v[240:241], v25 offset:0
    ds_read_b64 v[242:243], v25 offset:64
    ds_read_b64 v[244:245], v25 offset:128
    ds_read_b64 v[246:247], v25 offset:192
    ds_read_b128 v[224:227], v24 offset:0
    ds_read_b128 v[228:231], v24 offset:8192
    ds_read_b128 v[232:235], v24 offset:16384
    ds_read_b128 v[236:239], v24 offset:24576
    s_waitcnt lgkmcnt(4)
    v_max3_f32 v60, v240, v242, v244
    v_max_f32 v60, v60, v246
    v_sub_f32 v240, v240, v60
    v_sub_f32 v242, v242, v60
    v_sub_f32 v244, v244, v60
    v_sub_f32 v246, v246, v60
    v_exp_f32 v240, v240
    v_exp_f32 v242, v242
    v_exp_f32 v244, v244
    v_exp_f32 v246, v246
    s_nop 0
    v_mul_f32 v61, v240, v241
    v_fmac_f32 v61, v242, v243
    v_fmac_f32 v61, v244, v245
    v_fmac_f32 v61, v246, v247
    v_rcp_f32 v62, v61
    v_log_f32 v63, v61
    v_mov_b32 v49, s64
    v_mov_b32 v51, s64
    v_mul_f32 v240, v240, v62
    v_mul_f32 v242, v242, v62
    v_mul_f32 v244, v244, v62
    v_mul_f32 v246, v246, v62
    v_add_f32 v60, v60, v63
    v_mov_b32 v61, s64
    v_mov_b32 v63, s64
    v_mov_b32 v62, v60
    s_waitcnt lgkmcnt(0)
    v_mul_f32 v32, v224, v240
    v_mul_f32 v33, v225, v240
    v_mul_f32 v34, v226, v240
    v_mul_f32 v35, v227, v240
    v_fmac_f32 v32, v228, v242
    v_fmac_f32 v33, v229, v242
    v_fmac_f32 v34, v230, v242
    v_fmac_f32 v35, v231, v242
    v_fmac_f32 v32, v232, v244
    v_fmac_f32 v33, v233, v244
    v_fmac_f32 v34, v234, v244
    v_fmac_f32 v35, v235, v244
    v_fmac_f32 v32, v236, v246
    v_fmac_f32 v33, v237, v246
    v_fmac_f32 v34, v238, v246
    v_fmac_f32 v35, v239, v246
    v_cvt_pk_bf16_f32 v48, v32, v33
    v_cvt_pk_bf16_f32 v50, v34, v35
    buffer_store_dwordx4 v[48:51], v53, s[48:51], s67 offen sc1
    s_mov_b32 exec_lo, s92
    s_mov_b32 exec_hi, s92
    buffer_store_dwordx4 v[60:63], v54, s[48:51], s43 offen sc1
    s_mov_b64 exec, -1
    buffer_load_dwordx4 v[152:155], v8, s[44:47], s15 offen nt
    s_add_u32 s15, s15, 8192
    buffer_load_dwordx4 v[156:159], v8, s[44:47], s15 offen nt
    s_add_u32 s15, s15, 8192
    buffer_load_dwordx4 v[160:163], v8, s[44:47], s15 offen nt
    s_add_u32 s15, s15, 8192
    buffer_load_dwordx4 v[164:167], v8, s[44:47], s15 offen nt
    s_add_u32 s15, s15, 8192
    buffer_load_dwordx4 v[168:171], v8, s[44:47], s15 offen nt
    s_add_u32 s15, s15, 8192
    s_waitcnt vmcnt(2)
    s_mov_b64 exec, 1
    ds_add_u32 v26, v27 offset:28
    s_mov_b64 exec, -1
    s_mov_b32 s60, 1048576
L_xpj_4:
    ds_read_b32 v1, v26 offset:36
    s_sub_u32 s60, s60, 1
    s_cbranch_scc1 L_end
    s_waitcnt lgkmcnt(0)
    v_cmp_gt_u32 vcc, 1, v1
    s_cbranch_vccnz L_xpj_4
    buffer_load_dwordx4 v[172:175], v8, s[44:47], s15 offen nt
    s_add_u32 s15, s15, 8192
    buffer_load_dwordx4 v[176:179], v8, s[44:47], s15 offen nt
    s_add_u32 s15, s15, 8192
    buffer_load_dwordx4 v[180:183], v8, s[44:47], s15 offen nt
    s_add_u32 s15, s15, 8192
    buffer_load_dwordx4 v[184:187], v8, s[44:47], s15 offen nt
    s_add_u32 s15, s15, 8192
    buffer_load_dwordx4 v[188:191], v8, s[44:47], s15 offen nt
    s_mov_b32 s60, 1048576
L_go_5:
    ds_read_b32 v1, v26 offset:12
    s_sub_u32 s60, s60, 1
    s_cbranch_scc1 L_end
    s_waitcnt lgkmcnt(0)
    v_cmp_gt_u32 vcc, 1, v1
    s_cbranch_vccnz L_go_5
    ds_read_b128 v[40:43], v31
    ds_read_b128 v[44:47], v31 offset:16
    ds_read_b32 v29, v26 offset:24
    s_waitcnt lgkmcnt(0)
    v_perm_b32 v32, v40, v40, v10
    v_perm_b32 v33, v40, v40, v12
    v_perm_b32 v34, v40, v40, v14
    v_perm_b32 v35, v40, v40, v16
    v_perm_b32 v36, v40, v40, v11
    v_perm_b32 v37, v40, v40, v13
    v_perm_b32 v38, v40, v40, v15
    v_perm_b32 v39, v40, v40, v17
    s_waitcnt vmcnt(17)
    v_mfma_f32_16x16x32_bf16 v[18:21], v[32:35], v[128:131], 0
    v_perm_b32 v32, v41, v41, v10
    v_perm_b32 v33, v41, v41, v12
    v_perm_b32 v34, v41, v41, v14
    v_perm_b32 v35, v41, v41, v16
    s_waitcnt vmcnt(16)
    v_mfma_f32_16x16x32_bf16 v[18:21], v[36:39], v[132:135], v[18:21]
    v_perm_b32 v36, v41, v41, v11
    v_perm_b32 v37, v41, v41, v13
    v_perm_b32 v38, v41, v41, v15
    v_perm_b32 v39, v41, v41, v17
    s_waitcnt vmcnt(15)
    v_mfma_f32_16x16x32_bf16 v[18:21], v[32:35], v[136:139], v[18:21]
    v_perm_b32 v32, v42, v42, v10
    v_perm_b32 v33, v42, v42, v12
    v_perm_b32 v34, v42, v42, v14
    v_perm_b32 v35, v42, v42, v16
    s_waitcnt vmcnt(14)
    v_mfma_f32_16x16x32_bf16 v[18:21], v[36:39], v[140:143], v[18:21]
    v_perm_b32 v36, v42, v42, v11
    v_perm_b32 v37, v42, v42, v13
    v_perm_b32 v38, v42, v42, v15
    v_perm_b32 v39, v42, v42, v17
    s_waitcnt vmcnt(13)
    v_mfma_f32_16x16x32_bf16 v[18:21], v[32:35], v[144:147], v[18:21]
    v_perm_b32 v32, v43, v43, v10
    v_perm_b32 v33, v43, v43, v12
    v_perm_b32 v34, v43, v43, v14
    v_perm_b32 v35, v43, v43, v16
    s_waitcnt vmcnt(12)
    v_mfma_f32_16x16x32_bf16 v[18:21], v[36:39], v[148:151], v[18:21]
    v_perm_b32 v36, v43, v43, v11
    v_perm_b32 v37, v43, v43, v13
    v_perm_b32 v38, v43, v43, v15
    v_perm_b32 v39, v43, v43, v17
    s_waitcnt vmcnt(9)
    v_mfma_f32_16x16x32_bf16 v[18:21], v[32:35], v[152:155], v[18:21]
    v_perm_b32 v32, v44, v44, v10
    v_perm_b32 v33, v44, v44, v12
    v_perm_b32 v34, v44, v44, v14
    v_perm_b32 v35, v44, v44, v16
    s_waitcnt vmcnt(8)
    v_mfma_f32_16x16x32_bf16 v[18:21], v[36:39], v[156:159], v[18:21]
    v_perm_b32 v36, v44, v44, v11
    v_perm_b32 v37, v44, v44, v13
    v_perm_b32 v38, v44, v44, v15
    v_perm_b32 v39, v44, v44, v17
    s_waitcnt vmcnt(7)
    v_mfma_f32_16x16x32_bf16 v[18:21], v[32:35], v[160:163], v[18:21]
    v_perm_b32 v32, v45, v45, v10
    v_perm_b32 v33, v45, v45, v12
    v_perm_b32 v34, v45, v45, v14
    v_perm_b32 v35, v45, v45, v16
    s_waitcnt vmcnt(6)
    v_mfma_f32_16x16x32_bf16 v[18:21], v[36:39], v[164:167], v[18:21]
    v_perm_b32 v36, v45, v45, v11
    v_perm_b32 v37, v45, v45, v13
    v_perm_b32 v38, v45, v45, v15
    v_perm_b32 v39, v45, v45, v17
    s_waitcnt vmcnt(5)
    v_mfma_f32_16x16x32_bf16 v[18:21], v[32:35], v[168:171], v[18:21]
    v_perm_b32 v32, v46, v46, v10
    v_perm_b32 v33, v46, v46, v12
    v_perm_b32 v34, v46, v46, v14
    v_perm_b32 v35, v46, v46, v16
    s_waitcnt vmcnt(4)
    v_mfma_f32_16x16x32_bf16 v[18:21], v[36:39], v[172:175], v[18:21]
    v_perm_b32 v36, v46, v46, v11
    v_perm_b32 v37, v46, v46, v13
    v_perm_b32 v38, v46, v46, v15
    v_perm_b32 v39, v46, v46, v17
    s_waitcnt vmcnt(3)
    v_mfma_f32_16x16x32_bf16 v[18:21], v[32:35], v[176:179], v[18:21]
    v_perm_b32 v32, v47, v47, v10
    v_perm_b32 v33, v47, v47, v12
    v_perm_b32 v34, v47, v47, v14
    v_perm_b32 v35, v47, v47, v16
    s_waitcnt vmcnt(2)
    v_mfma_f32_16x16x32_bf16 v[18:21], v[36:39], v[180:183], v[18:21]
    v_perm_b32 v36, v47, v47, v11
    v_perm_b32 v37, v47, v47, v13
    v_perm_b32 v38, v47, v47, v15
    v_perm_b32 v39, v47, v47, v17
    s_waitcnt vmcnt(1)
    v_mfma_f32_16x16x32_bf16 v[18:21], v[32:35], v[184:187], v[18:21]
    s_waitcnt vmcnt(0)
    v_mfma_f32_16x16x32_bf16 v[18:21], v[36:39], v[188:191], v[18:21]
    v_mov_b32 v49, v29
    v_mov_b32 v51, v29
    s_nop 7
    v_permlane32_swap_b32 v18, v20
    v_permlane32_swap_b32 v19, v21
    s_nop 0
    v_mov_b32 v48, v18
    v_mov_b32 v50, v19
    buffer_store_dwordx4 v[48:51], v9, s[48:51], s61 offen sc1
    s_waitcnt vmcnt(0)
    s_mov_b64 exec, 1
    ds_add_u32 v26, v27 offset:32
    s_mov_b64 exec, -1
    s_endpgm
L_YG:
    s_mov_b32 s56, s28
    s_mov_b32 s57, s29
    s_cmp_lt_u32 s7, 112
    s_cselect_b32 s58, 7340032, 0
    s_mov_b32 s59, 0x00020000
    s_cselect_b32 s63, 0, 0x70000000
    s_add_u32 s63, s63, 3145728
    s_and_b32 s62, s7, 15
    s_lshr_b32 s65, s7, 4
    s_mul_i32 s14, s62, 458752
    s_lshl_b32 s10, s65, 10
    s_add_u32 s14, s14, s10
    v_lshrrev_b32 v1, 4, v0
    v_and_b32 v2, 15, v0
    v_mul_u32_u24 v6, 7168, v1
    v_lshl_add_u32 v6, v2, 4, v6
    s_lshl_b32 s10, s11, 8
    v_add_u32 v6, s10, v6
    s_lshl_b32 s10, s62, 7
    v_lshlrev_b32 v7, 1, v1
    v_add_u32 v7, s10, v7
    s_mul_i32 s10, s62, 28672
    s_add_u32 s63, s63, s10
    s_lshl_b32 s10, s65, 12
    s_add_u32 s63, s63, s10
    s_lshl_b32 s10, s11, 10
    s_add_u32 s63, s63, s10
    v_lshlrev_b32 v52, 6, v2
    v_and_b32 v2, 1, v1
    v_lshl_add_u32 v52, v2, 5, v52
    v_lshrrev_b32 v2, 1, v1
    v_lshl_add_u32 v52, v2, 4, v52
    s_mov_b32 s52, s32
    s_mov_b32 s53, s33
    s_mov_b32 s54, 7340032
    s_mov_b32 s55, 0x00020000
    s_lshl_b32 s10, s96, 6
    v_lshlrev_b32 v9, 1, v3
    v_add_u32 v30, 65536, v9
    v_add_u32 v30, s10, v30
    v_and_b32 v1, 1, v0
    v_cmp_eq_u32 vcc, 1, v1
    v_mov_b32 v1, 0x0c0c0100
    v_mov_b32 v2, 0x01000c0c
    v_cndmask_b32 v18, v1, v2, vcc
    v_mov_b32 v1, 0x0c0c0302
    v_mov_b32 v2, 0x03020c0c
    v_cndmask_b32 v19, v1, v2, vcc
    v_bfe_u32 v1, v0, 1, 2
    v_mov_b32 v2, 0x0c0c0c0c
    v_cmp_eq_u32 vcc, 0, v1
    s_nop 1
    v_cndmask_b32 v10, v2, v18, vcc
    v_cndmask_b32 v11, v2, v19, vcc
    v_cmp_eq_u32 vcc, 1, v1
    s_nop 1
    v_cndmask_b32 v12, v2, v18, vcc
    v_cndmask_b32 v13, v2, v19, vcc
    v_cmp_eq_u32 vcc, 2, v1
    s_nop 1
    v_cndmask_b32 v14, v2, v18, vcc
    v_cndmask_b32 v15, v2, v19, vcc
    v_cmp_eq_u32 vcc, 3, v1
    s_nop 1
    v_cndmask_b32 v16, v2, v18, vcc
    v_cndmask_b32 v17, v2, v19, vcc
    v_mov_b32 v26, 74240
    v_mov_b32 v27, 1
    v_lshlrev_b32 v28, 4, v0
    s_lshl_b32 s10, s11, 10
    v_add_u32 v28, s10, v28
    v_add_u32 v28, 67584, v28
    s_mul_i32 s15, s8, 114688
    s_lshl_b32 s10, s9, 10
    s_add_u32 s15, s15, s10
    v_lshrrev_b32 v1, 4, v0
    v_lshlrev_b32 v8, 11, v1
    v_and_b32 v2, 15, v0
    v_lshl_add_u32 v8, v2, 4, v8
    s_lshl_b32 s10, s11, 8
    v_add_u32 v8, s10, v8
    s_lshl_b32 s10, s9, 6
    s_lshl_b32 s61, s11, 4
    s_add_u32 s10, s10, s61
    v_add_u32 v2, s10, v2
    v_lshlrev_b32 v9, 13, v2
    v_and_b32 v2, 1, v1
    v_lshl_add_u32 v9, v2, 5, v9
    v_lshrrev_b32 v2, 1, v1
    v_lshl_add_u32 v9, v2, 4, v9
    s_lshl_b32 s61, s8, 6
    s_add_u32 s61, s61, 2101248
    v_lshlrev_b32 v1, 5, v1
    v_add_u32 v31, 73728, v1
    s_mov_b32 s60, 1048576
L_gx_6:
    ds_read_b32 v1, v26 offset:16
    s_sub_u32 s60, s60, 1
    s_cbranch_scc1 L_end
    s_waitcnt lgkmcnt(0)
    v_cmp_gt_u32 vcc, 1, v1
    s_cbranch_vccnz L_gx_6
    ds_read_u16 v40, v30 offset:0
    ds_read_u16 v41, v30 offset:64
    ds_read_u16 v42, v30 offset:128
    ds_read_u16 v43, v30 offset:192
    ds_read_u16 v44, v30 offset:256
    ds_read_u16 v45, v30 offset:320
    ds_read_u16 v46, v30 offset:384
    ds_read_u16 v47, v30 offset:448
    ds_read_b32 v29, v26 offset:24
    s_waitcnt lgkmcnt(0)
    v_readfirstlane_b32 s64, v29
    v_perm_b32 v32, v40, v40, v10
    v_perm_b32 v33, v40, v40, v12
    v_perm_b32 v34, v40, v40, v14
    v_perm_b32 v35, v40, v40, v16
    v_perm_b32 v36, v41, v41, v10
    v_perm_b32 v37, v41, v41, v12
    v_perm_b32 v38, v41, v41, v14
    v_perm_b32 v39, v41, v41, v16
    s_waitcnt vmcnt(7)
    v_mfma_f32_16x16x32_bf16 v[18:21], v[32:35], v[192:195], 0
    v_perm_b32 v32, v42, v42, v10
    v_perm_b32 v33, v42, v42, v12
    v_perm_b32 v34, v42, v42, v14
    v_perm_b32 v35, v42, v42, v16
    s_waitcnt vmcnt(6)
    v_mfma_f32_16x16x32_bf16 v[18:21], v[36:39], v[196:199], v[18:21]
    v_perm_b32 v36, v43, v43, v10
    v_perm_b32 v37, v43, v43, v12
    v_perm_b32 v38, v43, v43, v14
    v_perm_b32 v39, v43, v43, v16
    s_waitcnt vmcnt(5)
    v_mfma_f32_16x16x32_bf16 v[18:21], v[32:35], v[200:203], v[18:21]
    v_perm_b32 v32, v44, v44, v10
    v_perm_b32 v33, v44, v44, v12
    v_perm_b32 v34, v44, v44, v14
    v_perm_b32 v35, v44, v44, v16
    s_waitcnt vmcnt(4)
    v_mfma_f32_16x16x32_bf16 v[18:21], v[36:39], v[204:207], v[18:21]
    v_perm_b32 v36, v45, v45, v10
    v_perm_b32 v37, v45, v45, v12
    v_perm_b32 v38, v45, v45, v14
    v_perm_b32 v39, v45, v45, v16
    s_waitcnt vmcnt(3)
    v_mfma_f32_16x16x32_bf16 v[18:21], v[32:35], v[208:211], v[18:21]
    v_perm_b32 v32, v46, v46, v10
    v_perm_b32 v33, v46, v46, v12
    v_perm_b32 v34, v46, v46, v14
    v_perm_b32 v35, v46, v46, v16
    s_waitcnt vmcnt(2)
    v_mfma_f32_16x16x32_bf16 v[18:21], v[36:39], v[212:215], v[18:21]
    v_perm_b32 v36, v47, v47, v10
    v_perm_b32 v37, v47, v47, v12
    v_perm_b32 v38, v47, v47, v14
    v_perm_b32 v39, v47, v47, v16
    s_waitcnt vmcnt(1)
    v_mfma_f32_16x16x32_bf16 v[18:21], v[32:35], v[216:219], v[18:21]
    s_waitcnt vmcnt(0)
    v_mfma_f32_16x16x32_bf16 v[18:21], v[36:39], v[220:223], v[18:21]
    buffer_load_dwordx4 v[64:67], v6, s[56:59], s14 offen nt
    s_add_u32 s14, s14, 28672
    s_nop 7
    ds_write_b128 v28, v[18:21]
    s_mov_b64 exec, 1
    ds_add_u32 v26, v27 offset:0
    s_mov_b64 exec, -1
    v_and_b32 v1, 8, v0
    v_cmp_eq_u32 vcc, 0, v1
    v_mov_b32 v2, 0x0c0c0c0c
    s_nop 0
    v_cndmask_b32 v10, v2, v10, vcc
    v_cndmask_b32 v11, v2, v11, vcc
    v_cndmask_b32 v12, v2, v12, vcc
    v_cndmask_b32 v13, v2, v13, vcc
    v_cndmask_b32 v14, v2, v14, vcc
    v_cndmask_b32 v15, v2, v15, vcc
    v_cndmask_b32 v16, v2, v16, vcc
    v_cndmask_b32 v17, v2, v17, vcc
    s_mov_b32 s60, 1048576
L_gy_7:
    ds_read_b32 v1, v26 offset:20
    s_sub_u32 s60, s60, 1
    s_cbranch_scc1 L_end
    s_waitcnt lgkmcnt(0)
    v_cmp_gt_u32 vcc, 1, v1
    s_cbranch_vccnz L_gy_7
    ds_read_u16 v224, v7 offset:0
    ds_read_u16 v225, v7 offset:8
    ds_read_u16 v226, v7 offset:16
    ds_read_u16 v227, v7 offset:24
    ds_read_u16 v228, v7 offset:32
    ds_read_u16 v229, v7 offset:40
    ds_read_u16 v230, v7 offset:48
    ds_read_u16 v231, v7 offset:56
    ds_read_u16 v232, v7 offset:64
    ds_read_u16 v233, v7 offset:72
    ds_read_u16 v234, v7 offset:80
    ds_read_u16 v235, v7 offset:88
    ds_read_u16 v236, v7 offset:96
    ds_read_u16 v237, v7 offset:104
    ds_read_u16 v238, v7 offset:112
    ds_read_u16 v239, v7 offset:120
    s_waitcnt lgkmcnt(0)
    v_perm_b32 v32, v224, v224, v10
    v_perm_b32 v33, v224, v224, v12
    v_perm_b32 v34, v224, v224, v14
    v_perm_b32 v35, v224, v224, v16
    v_perm_b32 v36, v225, v225, v10
    v_perm_b32 v37, v225, v225, v12
    v_perm_b32 v38, v225, v225, v14
    v_perm_b32 v39, v225, v225, v16
    s_waitcnt vmcnt(0)
    v_mfma_f32_16x16x32_bf16 v[18:21], v[32:35], v[64:67], 0
    buffer_load_dwordx4 v[68:71], v6, s[56:59], s14 offen nt
    s_add_u32 s14, s14, 28672
    v_perm_b32 v32, v226, v226, v10
    v_perm_b32 v33, v226, v226, v12
    v_perm_b32 v34, v226, v226, v14
    v_perm_b32 v35, v226, v226, v16
    s_waitcnt vmcnt(0)
    v_mfma_f32_16x16x32_bf16 v[18:21], v[36:39], v[68:71], v[18:21]
    buffer_load_dwordx4 v[72:75], v6, s[56:59], s14 offen nt
    s_add_u32 s14, s14, 28672
    buffer_load_dwordx4 v[76:79], v6, s[56:59], s14 offen nt
    s_add_u32 s14, s14, 28672
    buffer_load_dwordx4 v[80:83], v6, s[56:59], s14 offen nt
    s_add_u32 s14, s14, 28672
    buffer_load_dwordx4 v[84:87], v6, s[56:59], s14 offen nt
    s_add_u32 s14, s14, 28672
    buffer_load_dwordx4 v[88:91], v6, s[56:59], s14 offen nt
    s_add_u32 s14, s14, 28672
    buffer_load_dwordx4 v[92:95], v6, s[56:59], s14 offen nt
    s_add_u32 s14, s14, 28672
    buffer_load_dwordx4 v[96:99], v6, s[56:59], s14 offen nt
    s_add_u32 s14, s14, 28672
    buffer_load_dwordx4 v[100:103], v6, s[56:59], s14 offen nt
    s_add_u32 s14, s14, 28672
    v_perm_b32 v36, v227, v227, v10
    v_perm_b32 v37, v227, v227, v12
    v_perm_b32 v38, v227, v227, v14
    v_perm_b32 v39, v227, v227, v16
    s_waitcnt vmcnt(7)
    v_mfma_f32_16x16x32_bf16 v[18:21], v[32:35], v[72:75], v[18:21]
    buffer_load_dwordx4 v[104:107], v6, s[56:59], s14 offen nt
    s_add_u32 s14, s14, 28672
    v_perm_b32 v32, v228, v228, v10
    v_perm_b32 v33, v228, v228, v12
    v_perm_b32 v34, v228, v228, v14
    v_perm_b32 v35, v228, v228, v16
    s_waitcnt vmcnt(7)
    v_mfma_f32_16x16x32_bf16 v[18:21], v[36:39], v[76:79], v[18:21]
    buffer_load_dwordx4 v[108:111], v6, s[56:59], s14 offen nt
    s_add_u32 s14, s14, 28672
    v_perm_b32 v36, v229, v229, v10
    v_perm_b32 v37, v229, v229, v12
    v_perm_b32 v38, v229, v229, v14
    v_perm_b32 v39, v229, v229, v16
    s_waitcnt vmcnt(7)
    v_mfma_f32_16x16x32_bf16 v[18:21], v[32:35], v[80:83], v[18:21]
    buffer_load_dwordx4 v[112:115], v6, s[56:59], s14 offen nt
    s_add_u32 s14, s14, 28672
    v_perm_b32 v32, v230, v230, v10
    v_perm_b32 v33, v230, v230, v12
    v_perm_b32 v34, v230, v230, v14
    v_perm_b32 v35, v230, v230, v16
    s_waitcnt vmcnt(7)
    v_mfma_f32_16x16x32_bf16 v[18:21], v[36:39], v[84:87], v[18:21]
    buffer_load_dwordx4 v[116:119], v6, s[56:59], s14 offen nt
    s_add_u32 s14, s14, 28672
    v_perm_b32 v36, v231, v231, v10
    v_perm_b32 v37, v231, v231, v12
    v_perm_b32 v38, v231, v231, v14
    v_perm_b32 v39, v231, v231, v16
    s_waitcnt vmcnt(7)
    v_mfma_f32_16x16x32_bf16 v[18:21], v[32:35], v[88:91], v[18:21]
    buffer_load_dwordx4 v[120:123], v6, s[56:59], s14 offen nt
    s_add_u32 s14, s14, 28672
    v_perm_b32 v32, v232, v232, v10
    v_perm_b32 v33, v232, v232, v12
    v_perm_b32 v34, v232, v232, v14
    v_perm_b32 v35, v232, v232, v16
    s_waitcnt vmcnt(7)
    v_mfma_f32_16x16x32_bf16 v[18:21], v[36:39], v[92:95], v[18:21]
    buffer_load_dwordx4 v[124:127], v6, s[56:59], s14 offen nt
    v_perm_b32 v36, v233, v233, v10
    v_perm_b32 v37, v233, v233, v12
    v_perm_b32 v38, v233, v233, v14
    v_perm_b32 v39, v233, v233, v16
    s_waitcnt vmcnt(7)
    v_mfma_f32_16x16x32_bf16 v[18:21], v[32:35], v[96:99], v[18:21]
    buffer_load_dwordx4 v[128:131], v8, s[52:55], s15 offen nt
    s_add_u32 s15, s15, 8192
    v_perm_b32 v32, v234, v234, v10
    v_perm_b32 v33, v234, v234, v12
    v_perm_b32 v34, v234, v234, v14
    v_perm_b32 v35, v234, v234, v16
    s_waitcnt vmcnt(7)
    v_mfma_f32_16x16x32_bf16 v[18:21], v[36:39], v[100:103], v[18:21]
    buffer_load_dwordx4 v[132:135], v8, s[52:55], s15 offen nt
    s_add_u32 s15, s15, 8192
    v_perm_b32 v36, v235, v235, v10
    v_perm_b32 v37, v235, v235, v12
    v_perm_b32 v38, v235, v235, v14
    v_perm_b32 v39, v235, v235, v16
    s_waitcnt vmcnt(7)
    v_mfma_f32_16x16x32_bf16 v[18:21], v[32:35], v[104:107], v[18:21]
    buffer_load_dwordx4 v[136:139], v8, s[52:55], s15 offen nt
    s_add_u32 s15, s15, 8192
    v_perm_b32 v32, v236, v236, v10
    v_perm_b32 v33, v236, v236, v12
    v_perm_b32 v34, v236, v236, v14
    v_perm_b32 v35, v236, v236, v16
    s_waitcnt vmcnt(7)
    v_mfma_f32_16x16x32_bf16 v[18:21], v[36:39], v[108:111], v[18:21]
    buffer_load_dwordx4 v[140:143], v8, s[52:55], s15 offen nt
    s_add_u32 s15, s15, 8192
    v_perm_b32 v36, v237, v237, v10
    v_perm_b32 v37, v237, v237, v12
    v_perm_b32 v38, v237, v237, v14
    v_perm_b32 v39, v237, v237, v16
    s_waitcnt vmcnt(7)
    v_mfma_f32_16x16x32_bf16 v[18:21], v[32:35], v[112:115], v[18:21]
    buffer_load_dwordx4 v[144:147], v8, s[52:55], s15 offen nt
    s_add_u32 s15, s15, 8192
    v_perm_b32 v32, v238, v238, v10
    v_perm_b32 v33, v238, v238, v12
    v_perm_b32 v34, v238, v238, v14
    v_perm_b32 v35, v238, v238, v16
    s_waitcnt vmcnt(7)
    v_mfma_f32_16x16x32_bf16 v[18:21], v[36:39], v[116:119], v[18:21]
    buffer_load_dwordx4 v[148:151], v8, s[52:55], s15 offen nt
    s_add_u32 s15, s15, 8192
    v_perm_b32 v36, v239, v239, v10
    v_perm_b32 v37, v239, v239, v12
    v_perm_b32 v38, v239, v239, v14
    v_perm_b32 v39, v239, v239, v16
    s_waitcnt vmcnt(7)
    v_mfma_f32_16x16x32_bf16 v[18:21], v[32:35], v[120:123], v[18:21]
    buffer_load_dwordx4 v[152:155], v8, s[52:55], s15 offen nt
    s_add_u32 s15, s15, 8192
    s_waitcnt vmcnt(7)
    v_mfma_f32_16x16x32_bf16 v[18:21], v[36:39], v[124:127], v[18:21]
    buffer_load_dwordx4 v[156:159], v8, s[52:55], s15 offen nt
    s_add_u32 s15, s15, 8192
    v_mov_b32 v49, s64
    v_mov_b32 v51, s64
    s_nop 7
    v_permlane32_swap_b32 v18, v20
    v_permlane32_swap_b32 v19, v21
    s_nop 0
    v_mov_b32 v48, v18
    v_mov_b32 v50, v19
    buffer_store_dwordx4 v[48:51], v52, s[48:51], s63 offen sc1
    s_waitcnt vmcnt(8)
    buffer_load_dwordx4 v[160:163], v8, s[52:55], s15 offen nt
    s_add_u32 s15, s15, 8192
    s_waitcnt vmcnt(3)
    s_mov_b64 exec, 1
    ds_add_u32 v26, v27 offset:4
    s_mov_b64 exec, -1
    s_mov_b32 s60, 1048576
L_ypj_8:
    ds_read_b32 v1, v26 offset:36
    s_sub_u32 s60, s60, 1
    s_cbranch_scc1 L_end
    s_waitcnt lgkmcnt(0)
    v_cmp_gt_u32 vcc, 1, v1
    s_cbranch_vccnz L_ypj_8
    buffer_load_dwordx4 v[164:167], v8, s[52:55], s15 offen nt
    s_add_u32 s15, s15, 8192
    buffer_load_dwordx4 v[168:171], v8, s[52:55], s15 offen nt
    s_add_u32 s15, s15, 8192
    buffer_load_dwordx4 v[172:175], v8, s[52:55], s15 offen nt
    s_add_u32 s15, s15, 8192
    buffer_load_dwordx4 v[176:179], v8, s[52:55], s15 offen nt
    s_add_u32 s15, s15, 8192
    buffer_load_dwordx4 v[180:183], v8, s[52:55], s15 offen nt
    s_mov_b32 s60, 1048576
L_go_9:
    ds_read_b32 v1, v26 offset:12
    s_sub_u32 s60, s60, 1
    s_cbranch_scc1 L_end
    s_waitcnt lgkmcnt(0)
    v_cmp_gt_u32 vcc, 1, v1
    s_cbranch_vccnz L_go_9
    ds_read_b128 v[40:43], v31
    ds_read_b128 v[44:47], v31 offset:16
    ds_read_b32 v29, v26 offset:24
    s_waitcnt lgkmcnt(0)
    v_perm_b32 v32, v40, v40, v10
    v_perm_b32 v33, v40, v40, v12
    v_perm_b32 v34, v40, v40, v14
    v_perm_b32 v35, v40, v40, v16
    v_perm_b32 v36, v40, v40, v11
    v_perm_b32 v37, v40, v40, v13
    v_perm_b32 v38, v40, v40, v15
    v_perm_b32 v39, v40, v40, v17
    s_waitcnt vmcnt(14)
    v_mfma_f32_16x16x32_bf16 v[18:21], v[32:35], v[128:131], 0
    v_perm_b32 v32, v41, v41, v10
    v_perm_b32 v33, v41, v41, v12
    v_perm_b32 v34, v41, v41, v14
    v_perm_b32 v35, v41, v41, v16
    s_waitcnt vmcnt(13)
    v_mfma_f32_16x16x32_bf16 v[18:21], v[36:39], v[132:135], v[18:21]
    v_perm_b32 v36, v41, v41, v11
    v_perm_b32 v37, v41, v41, v13
    v_perm_b32 v38, v41, v41, v15
    v_perm_b32 v39, v41, v41, v17
    s_waitcnt vmcnt(12)
    v_mfma_f32_16x16x32_bf16 v[18:21], v[32:35], v[136:139], v[18:21]
    v_perm_b32 v32, v42, v42, v10
    v_perm_b32 v33, v42, v42, v12
    v_perm_b32 v34, v42, v42, v14
    v_perm_b32 v35, v42, v42, v16
    s_waitcnt vmcnt(11)
    v_mfma_f32_16x16x32_bf16 v[18:21], v[36:39], v[140:143], v[18:21]
    v_perm_b32 v36, v42, v42, v11
    v_perm_b32 v37, v42, v42, v13
    v_perm_b32 v38, v42, v42, v15
    v_perm_b32 v39, v42, v42, v17
    s_waitcnt vmcnt(10)
    v_mfma_f32_16x16x32_bf16 v[18:21], v[32:35], v[144:147], v[18:21]
    v_perm_b32 v32, v43, v43, v10
    v_perm_b32 v33, v43, v43, v12
    v_perm_b32 v34, v43, v43, v14
    v_perm_b32 v35, v43, v43, v16
    s_waitcnt vmcnt(9)
    v_mfma_f32_16x16x32_bf16 v[18:21], v[36:39], v[148:151], v[18:21]
    v_perm_b32 v36, v43, v43, v11
    v_perm_b32 v37, v43, v43, v13
    v_perm_b32 v38, v43, v43, v15
    v_perm_b32 v39, v43, v43, v17
    s_waitcnt vmcnt(8)
    v_mfma_f32_16x16x32_bf16 v[18:21], v[32:35], v[152:155], v[18:21]
    v_perm_b32 v32, v44, v44, v10
    v_perm_b32 v33, v44, v44, v12
    v_perm_b32 v34, v44, v44, v14
    v_perm_b32 v35, v44, v44, v16
    s_waitcnt vmcnt(7)
    v_mfma_f32_16x16x32_bf16 v[18:21], v[36:39], v[156:159], v[18:21]
    v_perm_b32 v36, v44, v44, v11
    v_perm_b32 v37, v44, v44, v13
    v_perm_b32 v38, v44, v44, v15
    v_perm_b32 v39, v44, v44, v17
    s_waitcnt vmcnt(5)
    v_mfma_f32_16x16x32_bf16 v[18:21], v[32:35], v[160:163], v[18:21]
    v_perm_b32 v32, v45, v45, v10
    v_perm_b32 v33, v45, v45, v12
    v_perm_b32 v34, v45, v45, v14
    v_perm_b32 v35, v45, v45, v16
    s_waitcnt vmcnt(4)
    v_mfma_f32_16x16x32_bf16 v[18:21], v[36:39], v[164:167], v[18:21]
    v_perm_b32 v36, v45, v45, v11
    v_perm_b32 v37, v45, v45, v13
    v_perm_b32 v38, v45, v45, v15
    v_perm_b32 v39, v45, v45, v17
    s_waitcnt vmcnt(3)
    v_mfma_f32_16x16x32_bf16 v[18:21], v[32:35], v[168:171], v[18:21]
    v_perm_b32 v32, v46, v46, v10
    v_perm_b32 v33, v46, v46, v12
    v_perm_b32 v34, v46, v46, v14
    v_perm_b32 v35, v46, v46, v16
    s_waitcnt vmcnt(2)
    v_mfma_f32_16x16x32_bf16 v[18:21], v[36:39], v[172:175], v[18:21]
    v_perm_b32 v36, v46, v46, v11
    v_perm_b32 v37, v46, v46, v13
    v_perm_b32 v38, v46, v46, v15
    v_perm_b32 v39, v46, v46, v17
    s_waitcnt vmcnt(1)
    v_mfma_f32_16x16x32_bf16 v[18:21], v[32:35], v[176:179], v[18:21]
    s_waitcnt vmcnt(0)
    v_mfma_f32_16x16x32_bf16 v[18:21], v[36:39], v[180:183], v[18:21]
    v_mov_b32 v49, v29
    v_mov_b32 v51, v29
    s_nop 7
    v_permlane32_swap_b32 v18, v20
    v_permlane32_swap_b32 v19, v21
    s_nop 0
    v_mov_b32 v48, v18
    v_mov_b32 v50, v19
    buffer_store_dwordx4 v[48:51], v9, s[48:51], s61 offen sc1
    s_endpgm
L_H:
    s_mov_b32 s48, s40
    s_mov_b32 s49, s41
    s_mov_b32 s50, 268435456
    s_mov_b32 s51, 0x00020000
    v_mov_b32 v2, 74240
    v_mov_b32 v4, 0
    v_mov_b32 v5, 0
    ds_write_b64 v2, v[4:5] offset:0
    ds_write_b64 v2, v[4:5] offset:8
    ds_write_b64 v2, v[4:5] offset:16
    ds_write_b64 v2, v[4:5] offset:24
    ds_write_b64 v2, v[4:5] offset:32
    ds_write_b64 v2, v[4:5] offset:40
    s_waitcnt lgkmcnt(0)
    s_barrier
    v_lshlrev_b32 v6, 5, v0
    v_add_u32 v6, 65536, v6
    s_mov_b32 s44, 0
    s_mov_b32 s46, 0x3a800000
    s_waitcnt vmcnt(1)
L_LN:
    v_lshlrev_b32 v16, 16, v8
    v_and_b32 v17, 0xffff0000, v8
    v_lshlrev_b32 v18, 16, v9
    v_and_b32 v19, 0xffff0000, v9
    v_lshlrev_b32 v20, 16, v10
    v_and_b32 v21, 0xffff0000, v10
    v_lshlrev_b32 v22, 16, v11
    v_and_b32 v23, 0xffff0000, v11
    v_lshlrev_b32 v24, 16, v12
    v_and_b32 v25, 0xffff0000, v12
    v_lshlrev_b32 v26, 16, v13
    v_and_b32 v27, 0xffff0000, v13
    v_lshlrev_b32 v28, 16, v14
    v_and_b32 v29, 0xffff0000, v14
    v_lshlrev_b32 v30, 16, v15
    v_and_b32 v31, 0xffff0000, v15
    v_pk_add_f32 v[32:33], v[16:17], v[18:19]
    v_pk_add_f32 v[34:35], v[20:21], v[22:23]
    v_pk_add_f32 v[36:37], v[24:25], v[26:27]
    v_pk_add_f32 v[38:39], v[28:29], v[30:31]
    v_pk_add_f32 v[32:33], v[32:33], v[34:35]
    v_pk_add_f32 v[36:37], v[36:37], v[38:39]
    v_pk_add_f32 v[32:33], v[32:33], v[36:37]
    v_add_f32 v32, v32, v33
    s_nop 1
    v_add_f32_dpp v32, v32, v32 quad_perm:[1,0,3,2] row_mask:0xf bank_mask:0xf
    s_nop 1
    v_add_f32_dpp v32, v32, v32 quad_perm:[2,3,0,1] row_mask:0xf bank_mask:0xf
    s_nop 1
    v_add_f32_dpp v32, v32, v32 row_half_mirror row_mask:0xf bank_mask:0xf
    s_nop 1
    v_add_f32_dpp v32, v32, v32 row_mirror row_mask:0xf bank_mask:0xf
    v_mov_b32 v33, v32
    s_nop 1
    v_permlane16_swap_b32 v32, v33
    s_nop 0
    v_add_f32 v32, v32, v33
    v_mov_b32 v33, v32
    s_nop 1
    v_permlane32_swap_b32 v32, v33
    s_nop 0
    v_add_f32 v32, v32, v33
    v_mul_f32 v32, s46, v32
    v_cvt_pk_bf16_f32 v34, v32, v32
    v_and_b32 v34, 0xffff0000, v34
    v_pk_add_f32 v[40:41], v[16:17], v[32:33] op_sel_hi:[1,0] neg_lo:[0,1] neg_hi:[0,1]
    v_pk_add_f32 v[42:43], v[18:19], v[32:33] op_sel_hi:[1,0] neg_lo:[0,1] neg_hi:[0,1]
    v_pk_add_f32 v[44:45], v[20:21], v[32:33] op_sel_hi:[1,0] neg_lo:[0,1] neg_hi:[0,1]
    v_pk_add_f32 v[46:47], v[22:23], v[32:33] op_sel_hi:[1,0] neg_lo:[0,1] neg_hi:[0,1]
    v_pk_add_f32 v[48:49], v[24:25], v[32:33] op_sel_hi:[1,0] neg_lo:[0,1] neg_hi:[0,1]
    v_pk_add_f32 v[50:51], v[26:27], v[32:33] op_sel_hi:[1,0] neg_lo:[0,1] neg_hi:[0,1]
    v_pk_add_f32 v[52:53], v[28:29], v[32:33] op_sel_hi:[1,0] neg_lo:[0,1] neg_hi:[0,1]
    v_pk_add_f32 v[54:55], v[30:31], v[32:33] op_sel_hi:[1,0] neg_lo:[0,1] neg_hi:[0,1]
    v_pk_mul_f32 v[36:37], v[40:41], v[40:41]
    v_pk_mul_f32 v[38:39], v[42:43], v[42:43]
    v_pk_fma_f32 v[36:37], v[44:45], v[44:45], v[36:37]
    v_pk_fma_f32 v[38:39], v[46:47], v[46:47], v[38:39]
    v_pk_fma_f32 v[36:37], v[48:49], v[48:49], v[36:37]
    v_pk_fma_f32 v[38:39], v[50:51], v[50:51], v[38:39]
    v_pk_fma_f32 v[36:37], v[52:53], v[52:53], v[36:37]
    v_pk_fma_f32 v[38:39], v[54:55], v[54:55], v[38:39]
    v_pk_add_f32 v[36:37], v[36:37], v[38:39]
    v_add_f32 v36, v36, v37
    s_nop 1
    v_add_f32_dpp v36, v36, v36 quad_perm:[1,0,3,2] row_mask:0xf bank_mask:0xf
    s_nop 1
    v_add_f32_dpp v36, v36, v36 quad_perm:[2,3,0,1] row_mask:0xf bank_mask:0xf
    s_nop 1
    v_add_f32_dpp v36, v36, v36 row_half_mirror row_mask:0xf bank_mask:0xf
    s_nop 1
    v_add_f32_dpp v36, v36, v36 row_mirror row_mask:0xf bank_mask:0xf
    v_mov_b32 v37, v36
    s_nop 1
    v_permlane16_swap_b32 v36, v37
    s_nop 0
    v_add_f32 v36, v36, v37
    v_mov_b32 v37, v36
    s_nop 1
    v_permlane32_swap_b32 v36, v37
    s_nop 0
    v_add_f32 v36, v36, v37
    v_mul_f32 v36, s46, v36
    v_cvt_pk_bf16_f32 v36, v36, v36
    v_and_b32 v36, 0xffff0000, v36
    v_add_f32 v36, 0x3727c5ac, v36
    v_cvt_pk_bf16_f32 v36, v36, v36
    v_and_b32 v36, 0xffff0000, v36
    v_sqrt_f32 v36, v36
    s_nop 0
    v_cvt_pk_bf16_f32 v36, v36, v36
    v_and_b32 v36, 0xffff0000, v36
    v_rcp_f32 v36, v36
    v_pk_add_f32 v[40:41], v[16:17], v[34:35] op_sel_hi:[1,0] neg_lo:[0,1] neg_hi:[0,1]
    v_pk_add_f32 v[42:43], v[18:19], v[34:35] op_sel_hi:[1,0] neg_lo:[0,1] neg_hi:[0,1]
    v_pk_add_f32 v[44:45], v[20:21], v[34:35] op_sel_hi:[1,0] neg_lo:[0,1] neg_hi:[0,1]
    v_pk_add_f32 v[46:47], v[22:23], v[34:35] op_sel_hi:[1,0] neg_lo:[0,1] neg_hi:[0,1]
    v_pk_add_f32 v[48:49], v[24:25], v[34:35] op_sel_hi:[1,0] neg_lo:[0,1] neg_hi:[0,1]
    v_pk_add_f32 v[50:51], v[26:27], v[34:35] op_sel_hi:[1,0] neg_lo:[0,1] neg_hi:[0,1]
    v_pk_add_f32 v[52:53], v[28:29], v[34:35] op_sel_hi:[1,0] neg_lo:[0,1] neg_hi:[0,1]
    v_pk_add_f32 v[54:55], v[30:31], v[34:35] op_sel_hi:[1,0] neg_lo:[0,1] neg_hi:[0,1]
    v_cvt_pk_bf16_f32 v8, v40, v41
    v_cvt_pk_bf16_f32 v9, v42, v43
    v_cvt_pk_bf16_f32 v10, v44, v45
    v_cvt_pk_bf16_f32 v11, v46, v47
    v_cvt_pk_bf16_f32 v12, v48, v49
    v_cvt_pk_bf16_f32 v13, v50, v51
    v_cvt_pk_bf16_f32 v14, v52, v53
    v_cvt_pk_bf16_f32 v15, v54, v55
    v_lshlrev_b32 v16, 16, v8
    v_and_b32 v17, 0xffff0000, v8
    v_lshlrev_b32 v18, 16, v9
    v_and_b32 v19, 0xffff0000, v9
    v_lshlrev_b32 v20, 16, v10
    v_and_b32 v21, 0xffff0000, v10
    v_lshlrev_b32 v22, 16, v11
    v_and_b32 v23, 0xffff0000, v11
    v_lshlrev_b32 v24, 16, v12
    v_and_b32 v25, 0xffff0000, v12
    v_lshlrev_b32 v26, 16, v13
    v_and_b32 v27, 0xffff0000, v13
    v_lshlrev_b32 v28, 16, v14
    v_and_b32 v29, 0xffff0000, v14
    v_lshlrev_b32 v30, 16, v15
    v_and_b32 v31, 0xffff0000, v15
    v_pk_mul_f32 v[16:17], v[16:17], v[36:37] op_sel_hi:[1,0]
    v_pk_mul_f32 v[18:19], v[18:19], v[36:37] op_sel_hi:[1,0]
    v_pk_mul_f32 v[20:21], v[20:21], v[36:37] op_sel_hi:[1,0]
    v_pk_mul_f32 v[22:23], v[22:23], v[36:37] op_sel_hi:[1,0]
    v_pk_mul_f32 v[24:25], v[24:25], v[36:37] op_sel_hi:[1,0]
    v_pk_mul_f32 v[26:27], v[26:27], v[36:37] op_sel_hi:[1,0]
    v_pk_mul_f32 v[28:29], v[28:29], v[36:37] op_sel_hi:[1,0]
    v_pk_mul_f32 v[30:31], v[30:31], v[36:37] op_sel_hi:[1,0]
    v_cvt_pk_bf16_f32 v8, v16, v17
    v_cvt_pk_bf16_f32 v9, v18, v19
    v_cvt_pk_bf16_f32 v10, v20, v21
    v_cvt_pk_bf16_f32 v11, v22, v23
    v_cvt_pk_bf16_f32 v12, v24, v25
    v_cvt_pk_bf16_f32 v13, v26, v27
    v_cvt_pk_bf16_f32 v14, v28, v29
    v_cvt_pk_bf16_f32 v15, v30, v31
    ds_write_b128 v6, v[8:11]
    ds_write_b128 v6, v[12:15] offset:16
    v_mov_b32 v1, 1
    s_cmp_eq_u32 s44, 1
    s_cbranch_scc1 L_LN2_done
    s_waitcnt vmcnt(0)
    v_readfirstlane_b32 s64, v7
    s_nop 3
    s_mul_i32 s64, s64, 0x41c64e6d
    s_add_u32 s64, s64, 12345
    v_mov_b32 v7, s64
    ds_write_b32 v2, v7 offset:24
    ds_write_b32 v2, v1 offset:16
    s_mov_b32 s44, 1
    v_subrev_u32 v6, 65536, v6
    s_cmp_eq_u32 s6, 1
    s_cbranch_scc1 L_LN
L_LN2_done:
    ds_write_b32 v2, v1 offset:20
    v_bfe_u32 v1, v0, 1, 1
    v_lshlrev_b32 v1, 8, v1
    v_bfe_u32 v4, v0, 2, 3
    v_lshl_add_u32 v1, v4, 4, v1
    v_and_b32 v4, 1, v0
    v_lshl_add_u32 v3, v4, 3, v1
    v_add_u32 v3, 67584, v3
    v_lshlrev_b32 v4, 4, v0
    v_lshlrev_b32 v5, 3, v0
    s_lshr_b32 s10, s90, 4
    s_lshl_b32 s10, s10, 2
    s_add_u32 s10, s10, s42
    s_lshl_b32 s47, s10, 13
    s_and_b32 s10, s90, 15
    s_lshl_b32 s10, s10, 9
    s_add_u32 s47, s47, s10
    s_add_u32 s47, s47, 65536
    s_mov_b32 s60, 1048576
L_hp_10:
    ds_read_b32 v1, v2 offset:0
    s_sub_u32 s60, s60, 1
    s_cbranch_scc1 L_end
    s_waitcnt lgkmcnt(0)
    v_cmp_gt_u32 vcc, 4, v1
    s_cbranch_vccnz L_hp_10
    ds_read_b64 v[16:17], v3 offset:0
    ds_read_b64 v[18:19], v3 offset:640
    ds_read_b64 v[20:21], v3 offset:1024
    ds_read_b64 v[22:23], v3 offset:1664
    ds_read_b64 v[24:25], v3 offset:2048
    ds_read_b64 v[26:27], v3 offset:2688
    ds_read_b64 v[28:29], v3 offset:3072
    ds_read_b64 v[30:31], v3 offset:3712
    v_mov_b32 v41, s64
    v_mov_b32 v43, s64
    s_waitcnt lgkmcnt(0)
    v_pk_add_f32 v[16:17], v[16:17], v[18:19]
    v_pk_add_f32 v[20:21], v[20:21], v[22:23]
    v_pk_add_f32 v[24:25], v[24:25], v[26:27]
    v_pk_add_f32 v[28:29], v[28:29], v[30:31]
    v_pk_add_f32 v[16:17], v[16:17], v[20:21]
    v_pk_add_f32 v[24:25], v[24:25], v[28:29]
    v_pk_add_f32 v[16:17], v[16:17], v[24:25]
    v_mov_b32 v40, v16
    v_mov_b32 v42, v17
    s_mov_b32 exec_lo, 0xffffffff
    s_mov_b32 exec_hi, 0x0
    buffer_store_dwordx4 v[40:43], v4, s[48:51], s47 offen sc1
    s_mov_b64 exec, -1
    s_cmp_eq_u32 s6, 1
    s_cbranch_scc1 L_YH
    v_and_b32 v1, 3, v0
    v_lshlrev_b32 v1, 2, v1
    s_lshl_b32 s10, s7, 4
    v_add_u32 v60, s10, v1
    global_load_dword v61, v60, s[16:17]
    global_load_dword v62, v60, s[34:35]
    s_lshl_b32 s47, s8, 11
    s_add_u32 s47, s47, 393216
    s_lshl_b32 s52, s8, 13
    s_add_u32 s52, s52, 1048576
    v_lshrrev_b32 v1, 4, v0
    v_and_b32 v6, 15, v0
    v_lshlrev_b32 v6, 4, v6
    v_lshl_add_u32 v6, v1, 11, v6
    v_lshlrev_b32 v8, 5, v1
    v_add_u32 v8, 73856, v8
    v_and_b32 v9, 31, v0
    v_lshlrev_b32 v10, 6, v9
    v_lshlrev_b32 v9, 2, v9
    v_add_u32 v9, 73856, v9
    s_mov_b32 s60, 1048576
L_hs_11:
    ds_read_b32 v1, v2 offset:28
    s_sub_u32 s60, s60, 1
    s_cbranch_scc1 L_end
    s_waitcnt lgkmcnt(0)
    v_cmp_gt_u32 vcc, 4, v1
    s_cbranch_vccnz L_hs_11
    s_mov_b32 s60, 1048576
L_opoll:
    s_sleep 2
    buffer_load_dwordx2 v[16:17], v10, s[48:51], s47 offen sc1
    buffer_load_dwordx4 v[64:67], v6, s[48:51], s52 offen offset:0 sc1
    buffer_load_dwordx4 v[68:71], v6, s[48:51], s52 offen offset:256 sc1
    buffer_load_dwordx4 v[72:75], v6, s[48:51], s52 offen offset:512 sc1
    buffer_load_dwordx4 v[76:79], v6, s[48:51], s52 offen offset:768 sc1
    buffer_load_dwordx4 v[80:83], v6, s[48:51], s52 offen offset:1024 sc1
    buffer_load_dwordx4 v[84:87], v6, s[48:51], s52 offen offset:1280 sc1
    buffer_load_dwordx4 v[88:91], v6, s[48:51], s52 offen offset:1536 sc1
    buffer_load_dwordx4 v[92:95], v6, s[48:51], s52 offen offset:1792 sc1
    v_mov_b32 v1, 1
    ds_write_b32 v2, v1 offset:36
    s_sub_u32 s60, s60, 1
    s_cbranch_scc1 L_end
    s_waitcnt vmcnt(8)
    v_mov_b32 v20, v16
    s_nop 1
    v_max_f32_dpp v20, v20, v20 quad_perm:[1,0,3,2] row_mask:0xf bank_mask:0xf
    s_nop 1
    v_max_f32_dpp v20, v20, v20 quad_perm:[2,3,0,1] row_mask:0xf bank_mask:0xf
    s_nop 1
    v_max_f32_dpp v20, v20, v20 row_half_mirror row_mask:0xf bank_mask:0xf
    s_nop 1
    v_max_f32_dpp v20, v20, v20 row_mirror row_mask:0xf bank_mask:0xf
    v_mov_b32 v21, v20
    s_nop 1
    v_permlane16_swap_b32 v20, v21
    s_nop 0
    v_max_f32 v20, v20, v21
    v_mov_b32 v21, v20
    s_nop 1
    v_permlane32_swap_b32 v20, v21
    s_nop 0
    v_max_f32 v20, v20, v21
    v_sub_f32 v20, v16, v20
    v_exp_f32 v20, v20
    s_nop 0
    ds_write_b32 v9, v20
    v_mov_b32 v22, v20
    s_nop 1
    v_add_f32_dpp v22, v22, v22 quad_perm:[1,0,3,2] row_mask:0xf bank_mask:0xf
    s_nop 1
    v_add_f32_dpp v22, v22, v22 quad_perm:[2,3,0,1] row_mask:0xf bank_mask:0xf
    s_nop 1
    v_add_f32_dpp v22, v22, v22 row_half_mirror row_mask:0xf bank_mask:0xf
    s_nop 1
    v_add_f32_dpp v22, v22, v22 row_mirror row_mask:0xf bank_mask:0xf
    v_mov_b32 v21, v22
    s_nop 1
    v_permlane16_swap_b32 v22, v21
    s_nop 0
    v_add_f32 v22, v22, v21
    v_mov_b32 v21, v22
    s_nop 1
    v_permlane32_swap_b32 v22, v21
    s_nop 0
    v_add_f32 v22, v22, v21
    v_rcp_f32 v21, v22
    ds_read_b128 v[24:27], v8
    ds_read_b128 v[28:31], v8 offset:16
    v_min_u32 v11, s64, v17
    v_max_u32 v12, s64, v17
    v_add_f32 v21, v21, v21
    s_waitcnt vmcnt(0)
    v_min3_u32 v11, v11, v65, v67
    v_max3_u32 v12, v12, v65, v67
    v_min3_u32 v11, v11, v69, v71
    v_max3_u32 v12, v12, v69, v71
    v_min3_u32 v11, v11, v73, v75
    v_max3_u32 v12, v12, v73, v75
    v_min3_u32 v11, v11, v77, v79
    v_max3_u32 v12, v12, v77, v79
    v_min3_u32 v11, v11, v81, v83
    v_max3_u32 v12, v12, v81, v83
    v_min3_u32 v11, v11, v85, v87
    v_max3_u32 v12, v12, v85, v87
    v_min3_u32 v11, v11, v89, v91
    v_max3_u32 v12, v12, v89, v91
    v_min3_u32 v11, v11, v93, v95
    v_max3_u32 v12, v12, v93, v95
    v_cmp_ne_u32 vcc, v11, v12
    s_cbranch_vccnz L_opoll
    s_waitcnt lgkmcnt(0)
    v_lshlrev_b32 v48, 16, v64
    v_and_b32 v49, 0xffff0000, v64
    v_lshlrev_b32 v50, 16, v66
    v_and_b32 v51, 0xffff0000, v66
    v_mul_f32 v44, v48, v24
    v_mul_f32 v45, v49, v24
    v_mul_f32 v46, v50, v24
    v_mul_f32 v47, v51, v24
    v_lshlrev_b32 v48, 16, v68
    v_and_b32 v49, 0xffff0000, v68
    v_lshlrev_b32 v50, 16, v70
    v_and_b32 v51, 0xffff0000, v70
    v_fmac_f32 v44, v48, v25
    v_fmac_f32 v45, v49, v25
    v_fmac_f32 v46, v50, v25
    v_fmac_f32 v47, v51, v25
    v_lshlrev_b32 v48, 16, v72
    v_and_b32 v49, 0xffff0000, v72
    v_lshlrev_b32 v50, 16, v74
    v_and_b32 v51, 0xffff0000, v74
    v_fmac_f32 v44, v48, v26
    v_fmac_f32 v45, v49, v26
    v_fmac_f32 v46, v50, v26
    v_fmac_f32 v47, v51, v26
    v_lshlrev_b32 v48, 16, v76
    v_and_b32 v49, 0xffff0000, v76
    v_lshlrev_b32 v50, 16, v78
    v_and_b32 v51, 0xffff0000, v78
    v_fmac_f32 v44, v48, v27
    v_fmac_f32 v45, v49, v27
    v_fmac_f32 v46, v50, v27
    v_fmac_f32 v47, v51, v27
    v_lshlrev_b32 v48, 16, v80
    v_and_b32 v49, 0xffff0000, v80
    v_lshlrev_b32 v50, 16, v82
    v_and_b32 v51, 0xffff0000, v82
    v_fmac_f32 v44, v48, v28
    v_fmac_f32 v45, v49, v28
    v_fmac_f32 v46, v50, v28
    v_fmac_f32 v47, v51, v28
    v_lshlrev_b32 v48, 16, v84
    v_and_b32 v49, 0xffff0000, v84
    v_lshlrev_b32 v50, 16, v86
    v_and_b32 v51, 0xffff0000, v86
    v_fmac_f32 v44, v48, v29
    v_fmac_f32 v45, v49, v29
    v_fmac_f32 v46, v50, v29
    v_fmac_f32 v47, v51, v29
    v_lshlrev_b32 v48, 16, v88
    v_and_b32 v49, 0xffff0000, v88
    v_lshlrev_b32 v50, 16, v90
    v_and_b32 v51, 0xffff0000, v90
    v_fmac_f32 v44, v48, v30
    v_fmac_f32 v45, v49, v30
    v_fmac_f32 v46, v50, v30
    v_fmac_f32 v47, v51, v30
    v_lshlrev_b32 v48, 16, v92
    v_and_b32 v49, 0xffff0000, v92
    v_lshlrev_b32 v50, 16, v94
    v_and_b32 v51, 0xffff0000, v94
    v_fmac_f32 v44, v48, v31
    v_fmac_f32 v45, v49, v31
    v_fmac_f32 v46, v50, v31
    v_fmac_f32 v47, v51, v31
    v_mov_b32 v48, v44
    v_mov_b32 v49, v45
    v_mov_b32 v50, v46
    v_mov_b32 v51, v47
    s_nop 1
    v_permlane16_swap_b32 v44, v48
    v_permlane16_swap_b32 v45, v49
    v_permlane16_swap_b32 v46, v50
    v_permlane16_swap_b32 v47, v51
    s_nop 0
    v_add_f32 v44, v44, v48
    v_add_f32 v45, v45, v49
    v_add_f32 v46, v46, v50
    v_add_f32 v47, v47, v51
    v_mov_b32 v48, v44
    v_mov_b32 v49, v45
    v_mov_b32 v50, v46
    v_mov_b32 v51, v47
    s_nop 1
    v_permlane32_swap_b32 v44, v48
    v_permlane32_swap_b32 v45, v49
    v_permlane32_swap_b32 v46, v50
    v_permlane32_swap_b32 v47, v51
    s_nop 0
    v_add_f32 v44, v44, v48
    v_add_f32 v45, v45, v49
    v_add_f32 v46, v46, v50
    v_add_f32 v47, v47, v51
    v_mul_f32 v44, v44, v21
    v_mul_f32 v45, v45, v21
    v_mul_f32 v46, v46, v21
    v_mul_f32 v47, v47, v21
    v_cvt_pk_bf16_f32 v44, v44, v45
    v_cvt_pk_bf16_f32 v45, v46, v47
    v_lshlrev_b32 v5, 1, v0
    v_add_u32 v5, 73728, v5
    s_mov_b32 exec_lo, 0xffff
    s_mov_b32 exec_hi, 0x0
    ds_write_b16 v5, v44
    ds_write_b16_d16_hi v5, v44 offset:32
    ds_write_b16 v5, v45 offset:64
    ds_write_b16_d16_hi v5, v45 offset:96
    s_mov_b64 exec, -1
    v_mov_b32 v1, 1
    ds_write_b32 v2, v1 offset:12
    s_lshl_b32 s47, s7, 13
    s_add_u32 s47, s47, 2097152
    s_add_u32 s56, s47, 4096
    s_mov_b32 s52, s36
    s_mov_b32 s53, s37
    s_mov_b32 s54, 2048
    s_mov_b32 s55, 0x00020000
    v_lshlrev_b32 v56, 16, v61
    v_and_b32 v57, 0xffff0000, v61
    v_lshlrev_b32 v58, 16, v62
    v_and_b32 v59, 0xffff0000, v62
    s_mov_b32 s60, 1048576
L_hf_12:
    ds_read_b32 v1, v2 offset:32
    s_sub_u32 s60, s60, 1
    s_cbranch_scc1 L_end
    s_waitcnt lgkmcnt(0)
    v_cmp_gt_u32 vcc, 4, v1
    s_cbranch_vccnz L_hf_12
    s_mov_b32 s60, 1048576
L_fpoll:
    s_sleep 2
    buffer_load_dwordx4 v[64:67], v4, s[48:51], s47 offen offset:0 sc1
    buffer_load_dwordx4 v[68:71], v4, s[48:51], s47 offen offset:1024 sc1
    buffer_load_dwordx4 v[72:75], v4, s[48:51], s47 offen offset:2048 sc1
    buffer_load_dwordx4 v[76:79], v4, s[48:51], s47 offen offset:3072 sc1
    buffer_load_dwordx4 v[80:83], v4, s[48:51], s56 offen offset:0 sc1
    buffer_load_dwordx4 v[84:87], v4, s[48:51], s56 offen offset:1024 sc1
    buffer_load_dwordx4 v[88:91], v4, s[48:51], s56 offen offset:2048 sc1
    buffer_load_dwordx4 v[92:95], v4, s[48:51], s56 offen offset:3072 sc1
    s_sub_u32 s60, s60, 1
    s_cbranch_scc1 L_end
    s_waitcnt vmcnt(0)
    v_min3_u32 v10, v65, v67, s64
    v_max3_u32 v11, v65, v67, s64
    v_min3_u32 v10, v10, v69, v71
    v_max3_u32 v11, v11, v69, v71
    v_min3_u32 v10, v10, v73, v75
    v_max3_u32 v11, v11, v73, v75
    v_min3_u32 v10, v10, v77, v79
    v_max3_u32 v11, v11, v77, v79
    v_min3_u32 v10, v10, v81, v83
    v_max3_u32 v11, v11, v81, v83
    v_min3_u32 v10, v10, v85, v87
    v_max3_u32 v11, v11, v85, v87
    v_min3_u32 v10, v10, v89, v91
    v_max3_u32 v11, v11, v89, v91
    v_min3_u32 v10, v10, v93, v95
    v_max3_u32 v11, v11, v93, v95
    v_cmp_ne_u32 vcc, v10, v11
    s_cbranch_vccnz L_fpoll
    v_add_f32 v64, v64, v68
    v_add_f32 v66, v66, v70
    v_add_f32 v72, v72, v76
    v_add_f32 v74, v74, v78
    v_add_f32 v40, v64, v72
    v_add_f32 v41, v66, v74
    v_add_f32 v80, v80, v84
    v_add_f32 v82, v82, v86
    v_add_f32 v88, v88, v92
    v_add_f32 v90, v90, v94
    v_add_f32 v42, v80, v88
    v_add_f32 v43, v82, v90
    s_nop 0
    v_add_f32_dpp v40, v40, v40 row_ror:4 row_mask:0xf bank_mask:0xf
    v_add_f32_dpp v41, v41, v41 row_ror:4 row_mask:0xf bank_mask:0xf
    v_add_f32_dpp v42, v42, v42 row_ror:4 row_mask:0xf bank_mask:0xf
    v_add_f32_dpp v43, v43, v43 row_ror:4 row_mask:0xf bank_mask:0xf
    s_nop 0
    v_add_f32_dpp v40, v40, v40 row_ror:8 row_mask:0xf bank_mask:0xf
    v_add_f32_dpp v41, v41, v41 row_ror:8 row_mask:0xf bank_mask:0xf
    v_add_f32_dpp v42, v42, v42 row_ror:8 row_mask:0xf bank_mask:0xf
    v_add_f32_dpp v43, v43, v43 row_ror:8 row_mask:0xf bank_mask:0xf
    v_mov_b32 v44, v40
    v_mov_b32 v45, v41
    v_mov_b32 v46, v42
    v_mov_b32 v47, v43
    s_nop 1
    v_permlane16_swap_b32 v40, v44
    v_permlane16_swap_b32 v41, v45
    v_permlane16_swap_b32 v42, v46
    v_permlane16_swap_b32 v43, v47
    s_nop 0
    v_add_f32 v40, v40, v44
    v_add_f32 v41, v41, v45
    v_add_f32 v42, v42, v46
    v_add_f32 v43, v43, v47
    v_mov_b32 v44, v40
    v_mov_b32 v45, v41
    v_mov_b32 v46, v42
    v_mov_b32 v47, v43
    s_nop 1
    v_permlane32_swap_b32 v40, v44
    v_permlane32_swap_b32 v41, v45
    v_permlane32_swap_b32 v42, v46
    v_permlane32_swap_b32 v43, v47
    s_nop 0
    v_add_f32 v40, v40, v44
    v_add_f32 v41, v41, v45
    v_add_f32 v42, v42, v46
    v_add_f32 v43, v43, v47
    v_cvt_pk_bf16_f32 v40, v40, v41
    v_cvt_pk_bf16_f32 v42, v42, v43
    v_lshlrev_b32 v44, 16, v40
    v_and_b32 v45, 0xffff0000, v40
    v_lshlrev_b32 v46, 16, v42
    v_and_b32 v47, 0xffff0000, v42
    v_pk_add_f32 v[44:45], v[44:45], v[56:57]
    v_pk_add_f32 v[46:47], v[46:47], v[58:59]
    v_cvt_pk_bf16_f32 v40, v44, v45
    v_cvt_pk_bf16_f32 v42, v46, v47
    v_lshlrev_b32 v54, 16, v40
    v_and_b32 v55, 0xffff0000, v40
    v_lshlrev_b32 v52, 16, v42
    v_and_b32 v53, 0xffff0000, v42
    v_pk_add_f32 v[44:45], v[54:55], v[52:53]
    v_cvt_pk_bf16_f32 v40, v44, v45
    s_mov_b64 exec, 15
    buffer_store_dword v40, v60, s[52:55], 0 offen
    s_mov_b64 exec, 1
    s_cmp_eq_u32 s7, 0
    s_cbranch_scc0 L_XH_done
    v_mov_b32 v1, 0
    v_mov_b32 v2, s64
    buffer_store_dword v2, v1, s[48:51], 0 offen
L_XH_done:
    s_mov_b64 exec, -1
    s_endpgm
L_YH:
    s_mov_b32 s52, s30
    s_mov_b32 s53, s31
    s_mov_b32 s54, 7168
    s_mov_b32 s55, 0x00020000
    v_and_b32 v8, 31, v0
    s_mul_i32 s10, s8, 112
    v_lshlrev_b32 v1, 2, v8
    buffer_load_dword v63, v1, s[52:55], s10 offen
    s_mul_i32 s47, s8, 448
    s_add_u32 s47, s47, 3145728
    v_lshrrev_b32 v1, 5, v0
    v_mul_u32_u24 v9, 28672, v1
    v_lshl_add_u32 v9, v8, 4, v9
    v_and_b32 v1, 1, v8
    v_and_b32 v6, 30, v8
    v_lshl_add_u32 v6, v1, 6, v6
    v_add_u32 v6, 73728, v6
    s_mov_b32 s60, 1048576
L_hh_13:
    ds_read_b32 v1, v2 offset:4
    s_sub_u32 s60, s60, 1
    s_cbranch_scc1 L_end
    s_waitcnt lgkmcnt(0)
    v_cmp_gt_u32 vcc, 4, v1
    s_cbranch_vccnz L_hh_13
    s_mov_b32 s60, 1048576
L_hpoll:
    s_sleep 2
    s_mov_b32 exec_lo, 0xfffffff
    s_mov_b32 exec_hi, 0xfffffff
    s_mov_b32 s56, s47
    buffer_load_dwordx4 v[64:67], v9, s[48:51], s56 offen sc1
    s_add_u32 s56, s56, 57344
    buffer_load_dwordx4 v[68:71], v9, s[48:51], s56 offen sc1
    s_add_u32 s56, s56, 57344
    buffer_load_dwordx4 v[72:75], v9, s[48:51], s56 offen sc1
    s_add_u32 s56, s56, 57344
    buffer_load_dwordx4 v[76:79], v9, s[48:51], s56 offen sc1
    s_add_u32 s56, s56, 57344
    buffer_load_dwordx4 v[80:83], v9, s[48:51], s56 offen sc1
    s_add_u32 s56, s56, 57344
    buffer_load_dwordx4 v[84:87], v9, s[48:51], s56 offen sc1
    s_add_u32 s56, s56, 57344
    buffer_load_dwordx4 v[88:91], v9, s[48:51], s56 offen sc1
    s_add_u32 s56, s56, 57344
    buffer_load_dwordx4 v[92:95], v9, s[48:51], s56 offen sc1
    v_mov_b32 v1, 1
    ds_write_b32 v2, v1 offset:36
    s_sub_u32 s60, s60, 1
    s_cbranch_scc1 L_end
    s_waitcnt vmcnt(0)
    v_min3_u32 v10, v65, v67, s64
    v_max3_u32 v11, v65, v67, s64
    v_min3_u32 v10, v10, v69, v71
    v_max3_u32 v11, v11, v69, v71
    v_min3_u32 v10, v10, v73, v75
    v_max3_u32 v11, v11, v73, v75
    v_min3_u32 v10, v10, v77, v79
    v_max3_u32 v11, v11, v77, v79
    v_min3_u32 v10, v10, v81, v83
    v_max3_u32 v11, v11, v81, v83
    v_min3_u32 v10, v10, v85, v87
    v_max3_u32 v11, v11, v85, v87
    v_min3_u32 v10, v10, v89, v91
    v_max3_u32 v11, v11, v89, v91
    v_min3_u32 v10, v10, v93, v95
    v_max3_u32 v11, v11, v93, v95
    v_cmp_ne_u32 vcc, v10, v11
    s_cbranch_vccnz L_hpoll
    s_mov_b64 exec, -1
    v_add_f32 v64, v64, v80
    v_add_f32 v66, v66, v82
    v_add_f32 v68, v68, v84
    v_add_f32 v70, v70, v86
    v_add_f32 v72, v72, v88
    v_add_f32 v74, v74, v90
    v_add_f32 v76, v76, v92
    v_add_f32 v78, v78, v94
    v_add_f32 v64, v64, v72
    v_add_f32 v66, v66, v74
    v_add_f32 v68, v68, v76
    v_add_f32 v70, v70, v78
    v_add_f32 v64, v64, v68
    v_add_f32 v66, v66, v70
    v_mov_b32 v16, v64
    v_mov_b32 v17, v66
    v_mov_b32 v18, v64
    v_mov_b32 v19, v66
    s_nop 1
    v_permlane32_swap_b32 v16, v18
    v_permlane32_swap_b32 v17, v19
    s_nop 0
    v_pk_add_f32 v[16:17], v[16:17], v[18:19]
    v_cvt_pk_bf16_f32 v20, v16, v17
    v_lshlrev_b32 v16, 16, v20
    v_and_b32 v17, 0xffff0000, v20
    v_lshlrev_b32 v18, 16, v63
    v_and_b32 v19, 0xffff0000, v63
    v_pk_add_f32 v[16:17], v[16:17], v[18:19]
    v_cvt_pk_bf16_f32 v20, v16, v17
    v_lshlrev_b32 v16, 16, v20
    v_and_b32 v17, 0xffff0000, v20
    v_mul_f32 v18, v16, v16
    v_mul_f32 v19, v17, v17
    v_mul_f32 v18, 0x3d372713, v18
    v_mul_f32 v19, 0x3d372713, v19
    v_fma_f32 v18, v18, v16, v16
    v_fma_f32 v19, v19, v17, v17
    v_mul_f32 v18, 0xc0135761, v18
    v_mul_f32 v19, 0xc0135761, v19
    v_exp_f32 v18, v18
    v_exp_f32 v19, v19
    s_nop 0
    v_add_f32 v18, 1.0, v18
    v_add_f32 v19, 1.0, v19
    v_rcp_f32 v18, v18
    v_rcp_f32 v19, v19
    s_nop 0
    v_mul_f32 v16, v16, v18
    v_mul_f32 v17, v17, v19
    v_cvt_pk_bf16_f32 v16, v16, v17
    s_mov_b32 exec_lo, 0xfffffff
    s_mov_b32 exec_hi, 0x0
    ds_write_b16 v6, v16
    ds_write_b16_d16_hi v6, v16 offset:32
    s_mov_b64 exec, -1
    v_mov_b32 v1, 1
    ds_write_b32 v2, v1 offset:12
L_end:
    s_endpgm
L_code_end:
    .fill (16640 - (L_code_end - parallel_sum__sliding_block_cached__mixer_channel_mlp__decode_kernel))/4, 4, 0xBF800000
.section .rodata,"a"
.p2align 6
.amdhsa_kernel parallel_sum__sliding_block_cached__mixer_channel_mlp__decode_kernel
  .amdhsa_next_free_vgpr 248
  .amdhsa_next_free_sgpr 98
  .amdhsa_accum_offset 248
  .amdhsa_group_segment_fixed_size 0
  .amdhsa_kernarg_size 104
  .amdhsa_user_sgpr_count 2
  .amdhsa_user_sgpr_kernarg_segment_ptr 1
  .amdhsa_system_sgpr_workgroup_id_x 1
.end_amdhsa_kernel
```
